```python
import torch

def _softmax(x, axis=-1):
    return torch.softmax(x, dim=axis)

def _gelu(x):
    return torch.nn.functional.gelu(x, approximate='tanh')

def _silu(x):
    return torch.nn.functional.silu(x)

def _sigmoid(x):
    return torch.sigmoid(x)

def _layernorm(x, axis=-1, eps=1e-05):
    m = x.mean(dim=axis, keepdim=True)
    v = x.var(dim=axis, keepdim=True, unbiased=False)
    return (x - m) / torch.sqrt(v + eps)

def _scatter_add(tgt, idx, src, axis=0):
    return tgt.clone().index_add_(axis, idx, src)

def _segment_sum(src, seg, n):
    out = torch.zeros((n,) + src.shape[1:], dtype=src.dtype)
    return out.index_add_(0, seg, src)

def _pad(x, pw):
    flat = tuple((v for pair in reversed(pw) for v in pair))
    return torch.nn.functional.pad(x, flat)
kernel_name = 'standalone__factorization_afm__recsys'

def setup_inputs():

    _w = lambda a: (lambda t: t.to(torch.bfloat16) if t.is_floating_point() else t)(torch.as_tensor(a))
    B, F, D, V = (1024, 100, 32, min(1000000, 100000))
    A = D
    ii, jj = tuple(torch.triu_indices(F, F, 1).unbind(0))
    return {'idx': _w((lambda lo, hi, *s: torch.randint(lo, hi, s))(0, V, B, F).to(torch.int64)), 'table': _w((lambda *s: torch.randn(*s, dtype=torch.bfloat16) * 0.8)(V, D)), 'ii': _w(ii.to(torch.int64)), 'jj': _w(jj.to(torch.int64)), 'W': _w((lambda *s: torch.randn(*s, dtype=torch.bfloat16) * 0.8)(D, A) * (1.0 / D ** 0.5)), 'b': _w((lambda *s: torch.randn(*s, dtype=torch.bfloat16) * 0.8)(A)), 'h': _w((lambda *s: torch.randn(*s, dtype=torch.bfloat16) * 0.8)(A)), 'p': _w((lambda *s: torch.randn(*s, dtype=torch.bfloat16) * 0.8)(D))}

def reference(idx, table, ii, jj, W, b, h, p):
    emb = table[idx]
    ei = emb[:, ii, :].clone()
    ej = emb[:, jj, :].clone()
    pair = ei * ej
    hid = pair @ W + b
    hid = 0.5 * (hid + torch.abs(hid))
    e = hid @ h
    alpha = _softmax(e, axis=-1)
    pooled = torch.einsum('bp,bpd->bd', alpha, pair)
    return pooled @ p
```

```asm
; @launch grid=(256,1,1) block=(512,1,1) lds=63744
.amdgcn_target "amdgcn-amd-amdhsa--gfx950"
.text
.globl standalone__factorization_afm__recsys_kernel
.p2align 8
.type standalone__factorization_afm__recsys_kernel,@function
standalone__factorization_afm__recsys_kernel:
    s_load_dwordx2 s[4:5], s[0:1], 0
    s_load_dwordx2 s[8:9], s[0:1], 8
    s_load_dwordx8 s[12:19], s[0:1], 32
    s_load_dwordx2 s[28:29], s[0:1], 64
    s_bfe_u32 s57, s2, 0x20003
    s_getpc_b64 s[58:59]
    v_lshl_add_u32 v168, s57, 9, v0
    v_mul_u32_u24 v168, 12, v168
    v_mov_b32 v169, 0
    v_lshl_add_u64 v[168:169], v[168:169], 0, s[58:59]
    global_load_dword v168, v[168:169], off
    s_cmp_ge_u32 s2, 256
    s_cbranch_scc1 L_end
    s_and_b32 s3, s2, 7
    s_lshr_b32 s2, s2, 3
    s_lshl_b32 s3, s3, 5
    s_or_b32 s2, s2, s3
    v_lshrrev_b32 v144, 6, v0
    v_and_b32 v142, 15, v0
    s_mulk_i32 s2, 400
    v_bfe_u32 v148, v0, 3, 1
    v_lshl_add_u32 v165, v144, 3, v142
    v_mad_u32_u24 v165, v148, 56, v165
    v_readfirstlane_b32 s36, v144
    v_add_u32 v148, 28, v165
    v_lshrrev_b32 v148, 7, v148
    v_mul_u32_u24 v148, 36, v148
    v_sub_u32 v148, v165, v148
    v_add_lshl_u32 v153, v148, s2, 2
    v_and_b32 v151, 48, v0
    s_waitcnt lgkmcnt(0)
    global_load_dword v154, v153, s[4:5]
    global_load_dwordx4 v[126:129], v151, s[16:17]
    v_and_b32 v147, 12, v0
    v_add_u32 v147, v147, v142
    s_cmp_eq_u32 s36, 0
    s_cselect_b32 s37, 64, 0
    v_mad_u32_u24 v156, v147, s37, v151
    v_lshl_add_u32 v157, s37, 2, v156
    v_and_b32 v148, 0xf0, v0
    v_lshlrev_b32 v148, 1, v148
    v_add_lshl_u32 v158, v148, v142, 2
    s_cselect_b64 s[46:47], s[12:13], s[14:15]
    s_cmp_eq_u32 s36, 1
    s_cselect_b64 s[46:47], s[18:19], s[46:47]
    s_cmp_lt_u32 s36, 4
    s_cbranch_scc1 L_ld_s
    global_load_dword v86, v158, s[12:13]
    global_load_dword v87, v158, s[12:13] offset:64
    s_branch L_ld_end
L_ld_s:
    global_load_dwordx4 v[86:89], v156, s[46:47]
    global_load_dwordx4 v[90:93], v157, s[46:47]
L_ld_end:
    v_and_b32 v145, 31, v0
    v_bfe_u32 v146, v0, 5, 1
    v_lshlrev_b32 v161, 7, v151
    v_lshl_add_u32 v241, v165, 4, v161
    v_and_b32 v155, 63, v0
    v_lshlrev_b32 v155, 4, v155
    v_add_u32 v244, 53504, v155
    v_mov_b32 v219, 0
    s_mov_b32 s10, 6400000
    s_mov_b32 s11, 0x00020000
    s_mov_b32 s32, 0xffff0000
    s_mov_b32 s33, 0
    s_mov_b32 s38, 0x3f38aa3b
    s_mov_b32 s41, 0x7f800000
    s_movk_i32 s61, 2048
    s_cmp_eq_u32 s36, 1
    s_cselect_b32 s60, 0x41800000, s38
    s_cselect_b32 s39, 1.0, 0
    s_cmp_lt_u32 s36, 4
    s_cbranch_scc1 L_mid_w
    v_and_b32 v147, 13, v142
    v_and_b32 v148, 1, v142
    v_add_u32 v147, v147, v148
    v_and_b32 v148, 2, v142
    v_lshl_add_u32 v147, v148, 3, v147
    s_lshl_b32 s37, s36, 9
    s_add_u32 s37, s37, 51456
    v_lshrrev_b32 v148, 2, v151
    v_lshl_add_u32 v147, v147, 4, v148
    v_add_u32 v157, s37, v147
    s_branch L_mid_end
L_mid_w:
    s_cmp_ge_u32 s36, 2
    s_cbranch_scc1 L_mid_01
    v_mov_b32 v170, 0
    v_mov_b32 v171, 0
    v_mov_b32 v172, 0
    v_mov_b32 v173, 0
    v_add_u32 v147, 57600, v155
    s_lshl_b32 s44, 0x55555555, s36
    s_mov_b32 s45, s44
    s_lshl_b32 s48, 0x11111111, s36
    s_mov_b32 s49, s48
    s_lshl_b32 s50, s48, 2
    s_mov_b32 s51, s50
    v_cndmask_b32 v157, v147, v244, s[44:45]
    ds_write_b128 v157, v[170:173] offset:2048
    ds_write_b128 v157, v[170:173] offset:3072
    v_bfe_u32 v149, v142, 2, 1
    v_lshl_add_u32 v148, v149, 10, v244
    v_and_b32 v149, 8, v142
    v_add3_u32 v148, v148, v149, s61
    v_add_u32 v147, s61, v147
    v_cndmask_b32 v158, v147, v148, s[48:49]
    v_cndmask_b32 v159, v147, v148, s[50:51]
    s_branch L_mid_end
L_mid_01:
    s_cmp_lg_u32 s36, 2
    s_cbranch_scc1 L_mid_2
    ds_write_b32 v244, v219 offset:9216
    v_cmp_eq_u32 vcc, 4, v142
    v_mov_b32 v148, 0xf149f2ca
    v_lshlrev_b32 v147, 2, v142
    v_cndmask_b32 v148, 0, v148, vcc
    ds_write_b32 v147, v148 offset:32768
    s_branch L_mid_end
L_mid_2:
    v_and_b32 v147, 16, v0
    v_lshlrev_b32 v147, 2, v147
    v_lshl_add_u32 v157, v146, 4, v147
L_mid_end:
    v_lshlrev_b32 v152, 3, v144
    v_lshlrev_b32 v160, 11, v146
    v_lshl_add_u32 v222, v152, 4, v160
    v_add3_u32 v164, v152, 8, v142
    v_and_b32 v164, 63, v164
    v_add3_u32 v162, v152, 24, v142
    v_and_b32 v162, 63, v162
    v_cmp_gt_u32 vcc, 8, v142
    v_add_u32 v147, 88, v142
    v_xor_b32 v148, 32, v152
    v_cndmask_b32 v162, v147, v162, vcc
    v_cmp_gt_u32 vcc, 12, v142
    v_and_b32 v149, 4, v144
    v_add3_u32 v148, v148, v142, -12
    v_add_u32 v147, v148, v149
    v_xor_b32 v148, 4, v147
    v_cndmask_b32 v163, v148, v162, vcc
    v_cndmask_b32 v162, v147, v162, vcc
    v_cmp_gt_u32 vcc, 16, v145
    v_lshl_add_u32 v227, v142, 4, v161
    v_lshl_add_u32 v228, v164, 4, v161
    v_lshl_add_u32 v229, v162, 4, v161
    v_lshl_add_u32 v230, v163, 4, v161
    v_add_u32 v147, 64, v142
    v_add_u32 v148, 16, v147
    v_cndmask_b32 v149, v147, v162, vcc
    v_lshl_add_u32 v223, v149, 4, v160
    v_cndmask_b32 v149, v164, v148, vcc
    v_lshl_add_u32 v224, v149, 4, v160
    v_add_u32 v149, 64, v145
    v_lshl_add_u32 v225, v149, 4, v160
    v_cndmask_b32 v149, v163, v164, vcc
    v_lshl_add_u32 v226, v149, 4, v160
    v_lshrrev_b32 v147, 2, v142
    v_and_b32 v148, 2, v142
    v_lshl_add_u32 v147, v148, 1, v147
    v_add_u32 v147, v147, v152
    v_lshl_add_u32 v231, v147, 4, v161
    v_xor_b32 v232, 64, v231
    v_and_b32 v147, 7, v145
    v_lshrrev_b32 v148, 3, v145
    v_add3_u32 v148, v147, v148, 1
    v_and_b32 v148, 7, v148
    v_lshl_add_u32 v234, v147, 4, v222
    v_lshl_add_u32 v235, v148, 4, v222
    v_lshl_add_u32 v147, v144, 5, v145
    v_cmp_gt_u32 vcc, 68, v147
    v_lshrrev_b32 v148, 2, v147
    v_add_u32 v148, 1, v148
    v_and_or_b32 v149, v147, 3, 32
    v_add_u32 v150, -4, v145
    v_cndmask_b32 v148, 18, v148, vcc
    v_cndmask_b32 v149, v150, v149, vcc
    v_cmp_gt_u32 vcc, 3, v144
    v_add_u32 v150, 10, v144
    v_lshrrev_b32 v147, 1, v144
    v_cndmask_b32 v148, v150, v148, vcc
    v_cndmask_b32 v149, v145, v149, vcc
    v_add_u32 v149, 64, v149
    v_lshl_add_u32 v236, v149, 4, v160
    v_lshl_add_u32 v237, v148, 4, v236
    v_lshl_add_u32 v238, v147, 13, v225
    s_and_b32 s42, s36, 1
    s_mul_i32 s43, s42, 96
    v_add3_u32 v239, v238, s43, 16
    v_lshlrev_b32 v242, 3, v0
    v_add_u32 v242, 33024, v242
    s_lshr_b32 s43, s36, 1
    s_mulk_i32 s43, 5120
    s_lshl_b32 s42, s42, 9
    s_add_u32 s43, s43, s42
    s_add_u32 s43, s43, 37120
    v_lshrrev_b32 v149, 1, v155
    v_add_u32 v243, s43, v149
    s_cmp_eq_u32 s36, 2
    s_cselect_b32 s43, 0xffc00000, 0
    s_or_b32 s43, s43, 0xf000
    s_mov_b32 s42, 0
    v_cndmask_b32 v240, 0, 16, s[42:43]
    v_mov_b32 v149, 0x4444
    v_mov_b32 v150, 0xeeee
    s_mov_b32 s42, 0xf0f0f0f0
    s_mov_b32 s43, s42
    v_cndmask_b32 v1, v149, v150, s[42:43]
    s_mov_b32 s42, 0xcccccccc
    s_mov_b32 s43, s42
    v_cndmask_b32 v218, v149, v150, s[42:43]
    s_waitcnt vmcnt(3)
    v_lshl_add_u32 v154, v154, 6, v151
    buffer_load_dwordx4 v[130:133], v154, s[8:11], 0 offen
    s_waitcnt vmcnt(1)
    s_cmp_lt_u32 s36, 4
    s_cbranch_scc1 L_pr_s
    v_lshlrev_b32 v102, 16, v86
    v_and_b32 v103, s32, v86
    v_lshlrev_b32 v104, 16, v87
    v_and_b32 v105, s32, v87
    v_mul_f32 v102, s38, v102
    v_mul_f32 v103, s38, v103
    v_mul_f32 v104, s38, v104
    v_mul_f32 v105, s38, v105
    v_cvt_pk_f16_f32 v110, v102, v104
    v_cvt_pk_f16_f32 v111, v103, v105
    ds_write2_b32 v157, v110, v111 offset1:4
    v_max3_f32 v219, |v102|, |v103|, v219
    v_max3_f32 v219, |v104|, |v105|, v219
    v_mul_f32 v219, 0x3e804189, v219
    s_branch L_pr_end
L_pr_s:
    s_cmp_eq_u32 s36, 2
    s_cbranch_scc1 L_pr_h
    s_cmp_lg_u32 s36, 0
    s_cbranch_scc1 L_pr_u
    v_mfma_f32_16x16x32_bf16 v[102:105], v[86:89], v[126:129], 0
    v_mfma_f32_16x16x32_bf16 v[106:109], v[90:93], v[126:129], 0
    s_nop 6
    s_branch L_pr_m
L_pr_u:
    v_lshlrev_b32 v102, 16, v86
    v_and_b32 v103, s32, v86
    v_lshlrev_b32 v104, 16, v87
    v_and_b32 v105, s32, v87
    v_lshlrev_b32 v106, 16, v88
    v_and_b32 v107, s32, v88
    v_lshlrev_b32 v108, 16, v89
    v_and_b32 v109, s32, v89
L_pr_m:
    v_mul_f32 v102, s60, v102
    v_mul_f32 v103, s60, v103
    v_mul_f32 v104, s60, v104
    v_mul_f32 v105, s60, v105
    v_mul_f32 v106, s60, v106
    v_mul_f32 v107, s60, v107
    v_mul_f32 v108, s60, v108
    v_mul_f32 v109, s60, v109
    s_cmp_eq_u32 s36, 3
    s_cbranch_scc1 L_pr_b
    v_cvt_pk_f16_f32 v110, v102, v103
    v_cvt_pk_f16_f32 v111, v104, v105
    v_cvt_pk_f16_f32 v112, v106, v107
    v_cvt_pk_f16_f32 v113, v108, v109
    ds_write_b128 v157, v[110:113] offset:4096
    ds_write2_b32 v158, v110, v112 offset1:1
    ds_write2_b32 v159, v111, v113 offset1:1
    v_max3_f32 v219, |v102|, |v103|, v219
    v_max3_f32 v219, |v104|, |v105|, v219
    v_max3_f32 v219, |v106|, |v107|, v219
    v_max3_f32 v219, |v108|, |v109|, v219
    v_cmp_le_f32 vcc, s39, v219
    v_mul_f32 v219, 0x3e804189, v219
    s_nop 0
    s_cmp_eq_u64 vcc, 0
    s_cselect_b32 s33, s41, s33
    s_branch L_pr_end
L_pr_b:
    ds_write_b128 v157, v[102:105] offset:58624
    ds_write_b128 v157, v[106:109] offset:58656
    s_branch L_pr_end
L_pr_h:
    v_lshlrev_b32 v102, 16, v126
    v_and_b32 v103, s32, v126
    v_lshlrev_b32 v104, 16, v127
    v_and_b32 v105, s32, v127
    v_lshlrev_b32 v106, 16, v128
    v_and_b32 v107, s32, v128
    v_lshlrev_b32 v108, 16, v129
    v_and_b32 v109, s32, v129
    v_max3_f32 v219, |v102|, |v103|, v219
    v_max3_f32 v219, |v104|, |v105|, v219
    v_max3_f32 v219, |v106|, |v107|, v219
    v_max3_f32 v219, |v108|, |v109|, v219
    v_add_f32 v219, v219, v219
L_pr_end:
    global_load_dword v206, v153, s[4:5] offset:400
    global_load_dword v210, v153, s[4:5] offset:800
    global_load_dword v214, v153, s[4:5] offset:1200
    v_lshlrev_b32 v220, 6, v146
    s_waitcnt lgkmcnt(0)
    s_barrier
    ds_read_b128 v[2:5], v244 offset:0
    ds_read_b128 v[6:9], v244 offset:1024
    ds_read_b128 v[22:25], v220 offset:58624
    ds_read_b128 v[26:29], v220 offset:58640
    ds_read_b128 v[30:33], v220 offset:58656
    ds_read_b128 v[34:37], v220 offset:58672
    ds_read_b128 v[10:13], v244 offset:2048
    ds_read_b128 v[14:17], v244 offset:3072
    ds_read_b128 v[18:21], v244 offset:4096
    s_mov_b32 s42, 0x00440044
    s_mov_b32 s43, s42
    s_mov_b32 s44, 0x11001100
    s_mov_b32 s45, s44
    s_mov_b32 s46, 0x00110011
    s_mov_b32 s47, s46
    s_mov_b32 s48, 0x44004400
    s_mov_b32 s49, s48
    v_cndmask_b32 v40, 0, v126, s[42:43]
    v_cndmask_b32 v41, 0, v127, s[42:43]
    v_cndmask_b32 v48, 0, v128, s[42:43]
    v_cndmask_b32 v49, 0, v129, s[42:43]
    v_cndmask_b32 v42, 0, v126, s[44:45]
    v_cndmask_b32 v43, 0, v127, s[44:45]
    v_cndmask_b32 v50, 0, v128, s[44:45]
    v_cndmask_b32 v51, 0, v129, s[44:45]
    v_cndmask_b32 v38, 0, v126, s[46:47]
    v_cndmask_b32 v39, 0, v127, s[46:47]
    v_cndmask_b32 v46, 0, v128, s[46:47]
    v_cndmask_b32 v47, 0, v129, s[46:47]
    v_cndmask_b32 v44, 0, v126, s[48:49]
    v_cndmask_b32 v45, 0, v127, s[48:49]
    v_cndmask_b32 v52, 0, v128, s[48:49]
    v_cndmask_b32 v53, 0, v129, s[48:49]
    s_mov_b32 s30, 2048
    s_mov_b32 s31, 0x00020000
    s_mov_b32 s40, 0x3e000000
    s_mov_b32 s54, 0x43000000
    s_mul_i32 s57, s36, 5120
    s_lshr_b32 s58, s36, 2
    s_mov_b32 s59, 0
    s_mov_b64 vcc, s[58:59]
    v_mov_b32 v221, v151
    s_mul_hi_u32 s3, s2, 0x51eb852
    s_waitcnt vmcnt(3) lgkmcnt(0)
    .p2align 3
    v_lshlrev_b32_e64 v118, 16, v130
    v_and_b32_e64 v122, s32, v130
    v_lshlrev_b32_e64 v119, 16, v131
    v_and_b32_e64 v123, s32, v131
    v_lshlrev_b32_e64 v120, 16, v132
    v_and_b32_e64 v124, s32, v132
    v_lshlrev_b32_e64 v121, 16, v133
    v_and_b32_e64 v125, s32, v133
    v_cvt_pk_f16_f32 v130, v118, v122
    v_cvt_pk_f16_f32 v131, v119, v123
    v_cvt_pk_f16_f32 v132, v120, v124
    v_cvt_pk_f16_f32 v133, v121, v125
    ds_write_b128 v241, v[130:133]
    ds_read_b128 v[142:145], v234 offset:0
    ds_read_b128 v[146:149], v234 offset:4096
    ds_read_b128 v[150:153], v235 offset:0
    ds_read_b128 v[154:157], v235 offset:4096
    s_waitcnt lgkmcnt(4)
    s_barrier
    s_cbranch_vccz 1
    s_setprio 1
    ds_read_b128 v[158:161], v236 offset:0
    ds_read_b128 v[166:169], v237 offset:0
    ds_read_b128 v[162:165], v236 offset:4096
    ds_read_b128 v[170:173], v237 offset:4096
    ds_read_b128 v[174:177], v222 offset:0
    ds_read_b128 v[190:193], v223 offset:0
    s_waitcnt vmcnt(0)
    s_nop 0
    v_lshl_add_u32 v206, v206, 6, v221
    buffer_load_dwordx4 v[206:209], v206, s[8:11], 0 offen
    v_max3_f32 v219, |v118|, |v122|, v219
    v_max3_f32 v219, |v119|, |v123|, v219
    v_cmp_le_f32 s[34:35], s40, |v118|
    v_max3_f32 v219, |v120|, |v124|, v219
    v_max3_f32 v219, |v121|, |v125|, v219
    s_cmp_eq_u64 s[34:35], 0
    v_lshl_add_u32 v210, v210, 6, v221
    s_cselect_b32 s33, s41, s33
    v_lshl_add_u32 v214, v214, 6, v221
    ds_read_b128 v[178:181], v222 offset:4096
    ds_read_b128 v[194:197], v223 offset:4096
    ds_read_b128 v[182:185], v222 offset:16
    s_waitcnt lgkmcnt(10)
    s_nop 0
    v_pk_mul_f16 v150, v142, v150
    v_pk_mul_f16 v151, v143, v151
    v_pk_mul_f16 v152, v144, v152
    v_pk_mul_f16 v153, v145, v153
    s_waitcnt lgkmcnt(9)
    s_nop 0
    v_pk_mul_f16 v154, v146, v154
    v_pk_mul_f16 v155, v147, v155
    v_mfma_f32_32x32x16_f16 v[86:101], v[2:5], v[150:153], v[22:37]
    ds_read_b128 v[78:81], v240 offset:32768
    v_pk_mul_f16 v156, v148, v156
    v_pk_mul_f16 v157, v149, v157
    s_waitcnt lgkmcnt(6)
    s_nop 0
    v_pk_mul_f16 v166, v158, v166
    v_pk_mul_f16 v167, v159, v167
    v_pk_mul_f16 v168, v160, v168
    v_pk_mul_f16 v169, v161, v169
    v_mfma_f32_32x32x16_f16 v[86:101], v[6:9], v[154:157], v[86:101]
    ds_read_b128 v[186:189], v222 offset:4112
    v_pk_mul_f16 v170, v162, v170
    v_pk_mul_f16 v171, v163, v171
    v_pk_mul_f16 v172, v164, v172
    v_pk_mul_f16 v173, v165, v173
    s_waitcnt lgkmcnt(5)
    s_nop 0
    v_pk_mul_f16 v174, v2, v174
    v_pk_mul_f16 v175, v3, v175
    v_mfma_f32_32x32x16_f16 v[102:117], v[2:5], v[166:169], v[22:37]
    ds_read_b128 v[198:201], v224 offset:0
    v_pk_mul_f16 v176, v4, v176
    v_pk_mul_f16 v177, v5, v177
    ds_read_b128 v[202:205], v224 offset:4096
    ds_read_b128 v[134:137], v231 offset:0
    v_cvt_pk_bf16_f32 v118, |v86|, |v87|
    v_cvt_pk_bf16_f32 v120, |v88|, |v89|
    v_cvt_pk_bf16_f32 v122, |v90|, |v91|
    v_mfma_f32_32x32x16_f16 v[102:117], v[6:9], v[170:173], v[102:117]
    ds_read_b128 v[138:141], v232 offset:0
    v_cvt_pk_bf16_f32 v124, |v92|, |v93|
    v_cvt_pk_bf16_f32 v126, |v94|, |v95|
    v_cvt_pk_bf16_f32 v128, |v96|, |v97|
    v_cvt_pk_bf16_f32 v130, |v98|, |v99|
    v_cvt_pk_bf16_f32 v132, |v100|, |v101|
    v_mfma_f32_32x32x16_f16 v[86:101], v[174:177], v[190:193], v[22:37]
    ds_read_b128 v[58:61], v229 offset:0
    ds_read_b128 v[62:65], v227 offset:1024
    s_waitcnt lgkmcnt(7)
    s_nop 0
    v_pk_mul_f16 v178, v6, v178
    v_pk_mul_f16 v179, v7, v179
    v_pk_mul_f16 v180, v8, v180
    v_pk_mul_f16 v181, v9, v181
    v_cvt_pk_bf16_f32 v119, |v102|, |v103|
    v_cvt_pk_bf16_f32 v121, |v104|, |v105|
    v_mfma_f32_32x32x16_f16 v[86:101], v[178:181], v[194:197], v[86:101]
    ds_read_b128 v[142:145], v222 offset:32
    v_cvt_pk_bf16_f32 v123, |v106|, |v107|
    v_cvt_pk_bf16_f32 v125, |v108|, |v109|
    v_cvt_pk_bf16_f32 v127, |v110|, |v111|
    v_cvt_pk_bf16_f32 v129, |v112|, |v113|
    v_cvt_pk_bf16_f32 v131, |v114|, |v115|
    v_cvt_pk_bf16_f32 v133, |v116|, |v117|
    v_smfmac_f32_16x16x64_f16 v[78:81], v[10:13], v[150:157], v218
    ds_read_b128 v[146:149], v222 offset:4128
    v_pk_mul_f16 v182, v2, v182
    v_smfmac_f32_16x16x64_f16 v[78:81], v[14:17], v[166:173], v218
    ds_read_b128 v[158:161], v222 offset:48
    v_pk_mul_f16 v183, v3, v183
    v_smfmac_f32_16x16x64_bf16 v[78:81], v[40:43], v[118:125], v1
    ds_read_b128 v[66:69], v227 offset:1280
    v_pk_mul_f16 v184, v4, v184
    v_smfmac_f32_16x16x64_bf16 v[78:81], v[48:51], v[126:133], v1
    ds_read_b128 v[70:73], v228 offset:0
    v_pk_mul_f16 v185, v5, v185
    s_waitcnt lgkmcnt(7)
    s_nop 0
    v_pk_mul_f16 v186, v6, v186
    v_pk_mul_f16 v187, v7, v187
    v_mfma_f32_32x32x16_f16 v[102:117], v[182:185], v[190:193], v[22:37]
    ds_read_b128 v[162:165], v222 offset:4144
    v_pk_mul_f16 v188, v8, v188
    v_pk_mul_f16 v189, v9, v189
    v_cvt_pk_bf16_f32 v118, |v86|, |v87|
    v_cvt_pk_bf16_f32 v120, |v88|, |v89|
    v_cvt_pk_bf16_f32 v122, |v90|, |v91|
    v_cvt_pk_bf16_f32 v124, |v92|, |v93|
    v_mfma_f32_32x32x16_f16 v[102:117], v[186:189], v[194:197], v[102:117]
    ds_read_b128 v[150:153], v222 offset:64
    v_cvt_pk_bf16_f32 v126, |v94|, |v95|
    v_cvt_pk_bf16_f32 v128, |v96|, |v97|
    v_cvt_pk_bf16_f32 v130, |v98|, |v99|
    v_cvt_pk_bf16_f32 v132, |v100|, |v101|
    v_pk_mul_f16 v134, v134, v18
    v_pk_mul_f16 v135, v135, v19
    s_waitcnt lgkmcnt(6)
    s_nop 0
    v_mfma_f32_32x32x16_f16 v[86:101], v[174:177], v[198:201], v[22:37]
    ds_read_b128 v[174:177], v225 offset:0
    v_pk_mul_f16 v136, v136, v20
    v_pk_mul_f16 v137, v137, v21
    v_pk_mul_f16 v138, v138, v18
    v_cvt_pk_bf16_f32 v119, |v102|, |v103|
    v_cvt_pk_bf16_f32 v121, |v104|, |v105|
    v_cvt_pk_bf16_f32 v123, |v106|, |v107|
    v_mfma_f32_16x16x32_f16 v[62:65], v[134:137], v[62:65], 0
    ds_read_b128 v[154:157], v222 offset:4160
    v_cvt_pk_bf16_f32 v125, |v108|, |v109|
    v_cvt_pk_bf16_f32 v127, |v110|, |v111|
    v_mfma_f32_32x32x16_f16 v[86:101], v[178:181], v[202:205], v[86:101]
    ds_read_b128 v[178:181], v225 offset:4096
    v_cvt_pk_bf16_f32 v129, |v112|, |v113|
    v_cvt_pk_bf16_f32 v131, |v114|, |v115|
    v_cvt_pk_bf16_f32 v133, |v116|, |v117|
    v_pk_mul_f16 v139, v139, v19
    v_pk_mul_f16 v140, v140, v20
    v_pk_mul_f16 v141, v141, v21
    v_mfma_f32_32x32x16_f16 v[102:117], v[182:185], v[198:201], v[22:37]
    ds_read_b128 v[166:169], v222 offset:80
    v_pk_mul_f16 v142, v2, v142
    v_pk_mul_f16 v143, v3, v143
    v_pk_mul_f16 v144, v4, v144
    v_pk_mul_f16 v145, v5, v145
    s_waitcnt lgkmcnt(4)
    s_nop 0
    v_pk_mul_f16 v146, v6, v146
    v_pk_mul_f16 v147, v7, v147
    v_mfma_f32_16x16x32_f16 v[58:61], v[138:141], v[58:61], 0
    ds_read_b128 v[170:173], v222 offset:4176
    v_pk_mul_f16 v148, v8, v148
    v_pk_mul_f16 v149, v9, v149
    v_mfma_f32_16x16x32_f16 v[66:69], v[138:141], v[66:69], 0
    ds_read_b128 v[182:185], v226 offset:0
    v_pk_mul_f16 v158, v2, v158
    v_pk_mul_f16 v159, v3, v159
    v_mfma_f32_16x16x32_f16 v[70:73], v[134:137], v[70:73], 0
    ds_read_b128 v[74:77], v230 offset:0
    v_pk_mul_f16 v160, v4, v160
    v_pk_mul_f16 v161, v5, v161
    v_smfmac_f32_16x16x64_bf16 v[60:63], v[38:41], v[118:125], v1
    ds_read_b128 v[82:85], v240 offset:32768
    v_cvt_pk_bf16_f32 v118, |v86|, |v87|
    v_smfmac_f32_16x16x64_bf16 v[60:63], v[46:49], v[126:133], v1
    v_cvt_pk_bf16_f32 v120, |v88|, |v89|
    v_mfma_f32_32x32x16_f16 v[102:117], v[186:189], v[202:205], v[102:117]
    ds_read_b128 v[186:189], v226 offset:4096
    v_cvt_pk_bf16_f32 v122, |v90|, |v91|
    v_cvt_pk_bf16_f32 v124, |v92|, |v93|
    v_cvt_pk_bf16_f32 v126, |v94|, |v95|
    v_cvt_pk_bf16_f32 v128, |v96|, |v97|
    v_cvt_pk_bf16_f32 v130, |v98|, |v99|
    v_cvt_pk_bf16_f32 v132, |v100|, |v101|
    v_mfma_f32_32x32x16_f16 v[86:101], v[142:145], v[190:193], v[22:37]
    v_pk_mul_f16 v162, v6, v162
    v_pk_mul_f16 v163, v7, v163
    v_pk_mul_f16 v164, v8, v164
    v_pk_mul_f16 v165, v9, v165
    v_cvt_pk_bf16_f32 v119, |v102|, |v103|
    v_cvt_pk_bf16_f32 v121, |v104|, |v105|
    v_mfma_f32_32x32x16_f16 v[86:101], v[146:149], v[194:197], v[86:101]
    v_cvt_pk_bf16_f32 v123, |v106|, |v107|
    v_cvt_pk_bf16_f32 v125, |v108|, |v109|
    v_cvt_pk_bf16_f32 v127, |v110|, |v111|
    v_cvt_pk_bf16_f32 v129, |v112|, |v113|
    v_cvt_pk_bf16_f32 v131, |v114|, |v115|
    v_cvt_pk_bf16_f32 v133, |v116|, |v117|
    v_smfmac_f32_16x16x64_bf16 v[68:71], v[38:41], v[118:125], v1
    v_pk_mul_f16 v150, v2, v150
    v_smfmac_f32_16x16x64_bf16 v[68:71], v[46:49], v[126:133], v1
    v_pk_mul_f16 v151, v3, v151
    v_mfma_f32_32x32x16_f16 v[102:117], v[158:161], v[190:193], v[22:37]
    ds_read_b128 v[190:193], v222 offset:96
    v_cvt_pk_bf16_f32 v118, |v86|, |v87|
    v_cvt_pk_bf16_f32 v120, |v88|, |v89|
    v_cvt_pk_bf16_f32 v122, |v90|, |v91|
    v_cvt_pk_bf16_f32 v124, |v92|, |v93|
    v_cvt_pk_bf16_f32 v126, |v94|, |v95|
    v_cvt_pk_bf16_f32 v128, |v96|, |v97|
    s_waitcnt lgkmcnt(1)
    s_nop 0
    v_mfma_f32_16x16x32_f16 v[74:77], v[138:141], v[74:77], 0
    v_cvt_pk_bf16_f32 v130, |v98|, |v99|
    v_cvt_pk_bf16_f32 v132, |v100|, |v101|
    v_mfma_f32_32x32x16_f16 v[102:117], v[162:165], v[194:197], v[102:117]
    ds_read_b128 v[194:197], v222 offset:4192
    v_pk_mul_f16 v152, v4, v152
    v_pk_mul_f16 v153, v5, v153
    v_pk_mul_f16 v154, v6, v154
    v_pk_mul_f16 v155, v7, v155
    v_pk_mul_f16 v156, v8, v156
    v_pk_mul_f16 v157, v9, v157
    v_mfma_f32_32x32x16_f16 v[86:101], v[142:145], v[198:201], v[22:37]
    s_waitcnt vmcnt(0)
    buffer_load_dwordx4 v[210:213], v210, s[8:11], 0 offen
    buffer_load_dwordx4 v[214:217], v214, s[8:11], 0 offen
    buffer_store_dwordx2 v[18:19], off, s[28:31], s3
    v_lshlrev_b32_e32 v220, 16, v206
    v_and_b32_e64 v206, s32, v206
    v_cvt_pk_bf16_f32 v119, |v102|, |v103|
    v_cvt_pk_bf16_f32 v121, |v104|, |v105|
    v_mfma_f32_32x32x16_f16 v[86:101], v[146:149], v[202:205], v[86:101]
    ds_read_b128 v[142:145], v222 offset:112
    v_cvt_pk_bf16_f32 v123, |v106|, |v107|
    v_cvt_pk_bf16_f32 v125, |v108|, |v109|
    v_cvt_pk_bf16_f32 v127, |v110|, |v111|
    v_cvt_pk_bf16_f32 v129, |v112|, |v113|
    v_cvt_pk_bf16_f32 v131, |v114|, |v115|
    v_cvt_pk_bf16_f32 v133, |v116|, |v117|
    v_smfmac_f32_16x16x64_bf16 v[60:63], v[42:45], v[118:125], v1
    ds_read_b128 v[146:149], v222 offset:4208
    v_lshlrev_b32_e64 v221, 16, v207
    v_smfmac_f32_16x16x64_bf16 v[60:63], v[50:53], v[126:133], v1
    v_max3_f32 v219, |v220|, |v206|, v219
    s_waitcnt lgkmcnt(3)
    s_setprio 0
    v_mfma_f32_32x32x16_f16 v[102:117], v[158:161], v[198:201], v[22:37]
    v_and_b32_e64 v207, s32, v207
    v_cmp_le_f32 s[34:35], s40, |v220|
    v_cvt_pk_f16_f32 v206, v220, v206
    v_max3_f32 v219, |v221|, |v207|, v219
    s_cmp_eq_u64 s[34:35], 0
    v_cvt_pk_f16_f32 v207, v221, v207
    s_cselect_b32 s33, s41, s33
    v_mfma_f32_32x32x16_f16 v[102:117], v[162:165], v[202:205], v[102:117]
    v_lshlrev_b32_e64 v220, 16, v208
    v_and_b32_e64 v208, s32, v208
    v_lshlrev_b32_e64 v221, 16, v209
    v_max3_f32 v219, |v220|, |v208|, v219
    v_and_b32_e64 v209, s32, v209
    v_max3_f32 v219, |v221|, |v209|, v219
    v_cvt_pk_bf16_f32 v118, |v86|, |v87|
    v_cvt_pk_bf16_f32 v120, |v88|, |v89|
    v_cvt_pk_bf16_f32 v122, |v90|, |v91|
    v_cvt_pk_bf16_f32 v124, |v92|, |v93|
    v_cvt_pk_bf16_f32 v126, |v94|, |v95|
    v_cvt_pk_bf16_f32 v128, |v96|, |v97|
    v_cvt_pk_bf16_f32 v130, |v98|, |v99|
    v_cvt_pk_bf16_f32 v132, |v100|, |v101|
    v_cvt_pk_f16_f32 v208, v220, v208
    v_cvt_pk_f16_f32 v209, v221, v209
    v_mfma_f32_32x32x16_f16 v[86:101], v[150:153], v[174:177], v[22:37]
    ds_write_b128 v241, v[206:209] offset:8192
    v_cvt_pk_bf16_f32 v119, |v102|, |v103|
    v_cvt_pk_bf16_f32 v121, |v104|, |v105|
    v_cvt_pk_bf16_f32 v123, |v106|, |v107|
    v_cvt_pk_bf16_f32 v125, |v108|, |v109|
    v_cvt_pk_bf16_f32 v127, |v110|, |v111|
    v_cvt_pk_bf16_f32 v129, |v112|, |v113|
    v_smfmac_f32_16x16x64_bf16 v[68:71], v[42:45], v[118:125], v1
    v_cvt_pk_bf16_f32 v131, |v114|, |v115|
    v_mfma_f32_32x32x16_f16 v[86:101], v[154:157], v[178:181], v[86:101]
    v_cvt_pk_bf16_f32 v133, |v116|, |v117|
    v_pk_mul_f16 v166, v2, v166
    v_pk_mul_f16 v167, v3, v167
    v_pk_mul_f16 v168, v4, v168
    v_pk_mul_f16 v169, v5, v169
    v_pk_mul_f16 v170, v6, v170
    v_smfmac_f32_16x16x64_bf16 v[68:71], v[50:53], v[126:133], v1
    v_pk_mul_f16 v171, v7, v171
    v_mfma_f32_32x32x16_f16 v[102:117], v[166:169], v[174:177], v[22:37]
    v_pk_mul_f16 v172, v8, v172
    v_pk_mul_f16 v173, v9, v173
    v_pk_mul_f16 v190, v2, v190
    v_cvt_pk_bf16_f32 v118, |v86|, |v87|
    v_cvt_pk_bf16_f32 v120, |v88|, |v89|
    v_cvt_pk_bf16_f32 v122, |v90|, |v91|
    v_mfma_f32_32x32x16_f16 v[102:117], v[170:173], v[178:181], v[102:117]
    v_cvt_pk_bf16_f32 v124, |v92|, |v93|
    v_cvt_pk_bf16_f32 v126, |v94|, |v95|
    v_cvt_pk_bf16_f32 v128, |v96|, |v97|
    v_cvt_pk_bf16_f32 v130, |v98|, |v99|
    v_cvt_pk_bf16_f32 v132, |v100|, |v101|
    v_pk_mul_f16 v191, v3, v191
    s_waitcnt lgkmcnt(0)
    v_mfma_f32_32x32x16_f16 v[86:101], v[150:153], v[182:185], v[22:37]
    s_barrier
    v_pk_mul_f16 v192, v4, v192
    v_pk_mul_f16 v193, v5, v193
    v_pk_mul_f16 v194, v6, v194
    v_pk_mul_f16 v195, v7, v195
    v_cvt_pk_bf16_f32 v119, |v102|, |v103|
    v_cvt_pk_bf16_f32 v121, |v104|, |v105|
    v_mfma_f32_32x32x16_f16 v[86:101], v[154:157], v[186:189], v[86:101]
    ds_read_b128 v[158:161], v234 offset:8192
    v_cvt_pk_bf16_f32 v123, |v106|, |v107|
    v_cvt_pk_bf16_f32 v125, |v108|, |v109|
    v_cvt_pk_bf16_f32 v127, |v110|, |v111|
    v_cvt_pk_bf16_f32 v129, |v112|, |v113|
    v_cvt_pk_bf16_f32 v131, |v114|, |v115|
    v_cvt_pk_bf16_f32 v133, |v116|, |v117|
    v_smfmac_f32_16x16x64_bf16 v[64:67], v[38:41], v[118:125], v1
    ds_read_b128 v[198:201], v235 offset:8192
    v_pk_mul_f16 v196, v8, v196
    v_smfmac_f32_16x16x64_bf16 v[64:67], v[46:49], v[126:133], v1
    ds_read_b128 v[162:165], v234 offset:12288
    v_cvt_pk_bf16_f32 v118, |v86|, |v87|
    s_cbranch_vccz 1
    s_setprio 1
    v_mfma_f32_32x32x16_f16 v[102:117], v[166:169], v[182:185], v[22:37]
    ds_read_b128 v[202:205], v235 offset:12288
    v_cvt_pk_bf16_f32 v120, |v88|, |v89|
    v_cvt_pk_bf16_f32 v122, |v90|, |v91|
    v_cvt_pk_bf16_f32 v124, |v92|, |v93|
    v_cvt_pk_bf16_f32 v126, |v94|, |v95|
    v_cvt_pk_bf16_f32 v128, |v96|, |v97|
    v_cvt_pk_bf16_f32 v130, |v98|, |v99|
    v_mfma_f32_32x32x16_f16 v[102:117], v[170:173], v[186:189], v[102:117]
    ds_read_b128 v[150:153], v236 offset:8192
    v_cvt_pk_bf16_f32 v132, |v100|, |v101|
    v_pk_mul_f16 v197, v9, v197
    v_pk_mul_f16 v142, v2, v142
    v_pk_mul_f16 v143, v3, v143
    v_pk_mul_f16 v144, v4, v144
    v_pk_mul_f16 v145, v5, v145
    v_mfma_f32_32x32x16_f16 v[86:101], v[190:193], v[174:177], v[22:37]
    ds_read_b128 v[166:169], v237 offset:8192
    v_pk_mul_f16 v146, v6, v146
    v_pk_mul_f16 v147, v7, v147
    v_pk_mul_f16 v148, v8, v148
    v_cvt_pk_bf16_f32 v119, |v102|, |v103|
    v_cvt_pk_bf16_f32 v121, |v104|, |v105|
    v_cvt_pk_bf16_f32 v123, |v106|, |v107|
    v_mfma_f32_32x32x16_f16 v[86:101], v[194:197], v[178:181], v[86:101]
    ds_read_b128 v[154:157], v236 offset:12288
    v_cvt_pk_bf16_f32 v125, |v108|, |v109|
    v_cvt_pk_bf16_f32 v127, |v110|, |v111|
    v_cvt_pk_bf16_f32 v129, |v112|, |v113|
    v_cvt_pk_bf16_f32 v131, |v114|, |v115|
    v_cvt_pk_bf16_f32 v133, |v116|, |v117|
    v_pk_mul_f16 v149, v9, v149
    v_smfmac_f32_16x16x64_bf16 v[72:75], v[38:41], v[118:125], v1
    ds_read_b128 v[170:173], v237 offset:12288
    v_add_f32_e64 v78, v78, v80
    v_smfmac_f32_16x16x64_bf16 v[72:75], v[46:49], v[126:133], v1
    ds_read_b128 v[134:137], v231 offset:8192
    v_cvt_pk_bf16_f32 v118, |v86|, |v87|
    v_mfma_f32_32x32x16_f16 v[102:117], v[142:145], v[174:177], v[22:37]
    ds_read_b128 v[174:177], v222 offset:8192
    v_cvt_pk_bf16_f32 v120, |v88|, |v89|
    v_cvt_pk_bf16_f32 v122, |v90|, |v91|
    v_cvt_pk_bf16_f32 v124, |v92|, |v93|
    v_cvt_pk_bf16_f32 v126, |v94|, |v95|
    v_cvt_pk_bf16_f32 v128, |v96|, |v97|
    v_cvt_pk_bf16_f32 v130, |v98|, |v99|
    v_mfma_f32_32x32x16_f16 v[102:117], v[146:149], v[178:181], v[102:117]
    ds_read_b128 v[178:181], v222 offset:12288
    v_cvt_pk_bf16_f32 v132, |v100|, |v101|
    s_waitcnt lgkmcnt(5)
    s_nop 0
    v_pk_mul_f16 v198, v158, v198
    v_pk_mul_f16 v199, v159, v199
    v_pk_mul_f16 v200, v160, v200
    v_pk_mul_f16 v201, v161, v201
    v_pk_mul_f16 v202, v162, v202
    v_mfma_f32_32x32x16_f16 v[86:101], v[190:193], v[182:185], v[22:37]
    ds_read_b128 v[190:193], v222 offset:8208
    v_pk_mul_f16 v203, v163, v203
    v_pk_mul_f16 v204, v164, v204
    v_pk_mul_f16 v205, v165, v205
    v_cvt_pk_bf16_f32 v119, |v102|, |v103|
    v_cvt_pk_bf16_f32 v121, |v104|, |v105|
    v_cvt_pk_bf16_f32 v123, |v106|, |v107|
    v_smfmac_f32_16x16x64_f16 v[82:85], v[10:13], v[198:205], v218
    ds_read_b128 v[138:141], v232 offset:8192
    v_cvt_pk_bf16_f32 v125, |v108|, |v109|
    v_mfma_f32_32x32x16_f16 v[86:101], v[194:197], v[186:189], v[86:101]
    ds_read_b128 v[194:197], v222 offset:12304
    v_cvt_pk_bf16_f32 v127, |v110|, |v111|
    v_cvt_pk_bf16_f32 v129, |v112|, |v113|
    v_cvt_pk_bf16_f32 v131, |v114|, |v115|
    v_cvt_pk_bf16_f32 v133, |v116|, |v117|
    v_exp_f32_e64 v54, v78
    v_smfmac_f32_16x16x64_bf16 v[64:67], v[42:45], v[118:125], v1
    ds_read_b128 v[158:161], v222 offset:8224
    v_add_f32_e64 v79, v79, v81
    v_smfmac_f32_16x16x64_bf16 v[64:67], v[50:53], v[126:133], v1
    ds_read_b128 v[162:165], v222 offset:12320
    v_pk_mul_f16 v166, v150, v166
    v_mfma_f32_32x32x16_f16 v[102:117], v[142:145], v[182:185], v[22:37]
    ds_read_b128 v[142:145], v223 offset:8192
    v_cvt_pk_bf16_f32 v118, |v86|, |v87|
    v_cvt_pk_bf16_f32 v120, |v88|, |v89|
    v_cvt_pk_bf16_f32 v122, |v90|, |v91|
    v_cvt_pk_bf16_f32 v124, |v92|, |v93|
    v_cvt_pk_bf16_f32 v126, |v94|, |v95|
    v_cvt_pk_bf16_f32 v128, |v96|, |v97|
    v_mfma_f32_32x32x16_f16 v[102:117], v[146:149], v[186:189], v[102:117]
    ds_read_b128 v[146:149], v223 offset:12288
    v_cvt_pk_bf16_f32 v130, |v98|, |v99|
    v_cvt_pk_bf16_f32 v132, |v100|, |v101|
    v_pk_mul_f16 v167, v151, v167
    v_pk_mul_f16 v168, v152, v168
    v_pk_mul_f16 v169, v153, v169
    v_exp_f32_e64 v60, v60
    v_mfma_f32_32x32x16_f16 v[86:101], v[2:5], v[198:201], v[22:37]
    ds_read_b128 v[182:185], v224 offset:8192
    v_mul_f32_e64 v55, v54, v79
    v_exp_f32_e64 v62, v62
    v_add_f32_e64 v54, v54, v60
    v_cvt_pk_bf16_f32 v119, |v102|, |v103|
    v_cvt_pk_bf16_f32 v121, |v104|, |v105|
    v_mfma_f32_32x32x16_f16 v[86:101], v[6:9], v[202:205], v[86:101]
    ds_read_b128 v[186:189], v224 offset:12288
    v_cvt_pk_bf16_f32 v123, |v106|, |v107|
    v_cvt_pk_bf16_f32 v125, |v108|, |v109|
    v_cvt_pk_bf16_f32 v127, |v110|, |v111|
    v_cvt_pk_bf16_f32 v129, |v112|, |v113|
    v_cvt_pk_bf16_f32 v131, |v114|, |v115|
    v_cvt_pk_bf16_f32 v133, |v116|, |v117|
    v_smfmac_f32_16x16x64_bf16 v[72:75], v[42:45], v[118:125], v1
    ds_read_b128 v[150:153], v222 offset:8240
    v_fmac_f32_e64 v55, v60, v61
    v_smfmac_f32_16x16x64_bf16 v[72:75], v[50:53], v[126:133], v1
    ds_read_b128 v[58:61], v229 offset:8192
    v_exp_f32_e64 v68, v68
    v_mfma_f32_32x32x16_f16 v[102:117], v[2:5], v[166:169], v[22:37]
    ds_read_b128 v[198:201], v222 offset:8256
    v_add_f32_e64 v54, v54, v62
    v_fmac_f32_e64 v55, v62, v63
    v_exp_f32_e64 v70, v70
    v_add_f32_e64 v54, v54, v68
    v_fmac_f32_e64 v55, v68, v69
    v_exp_f32_e64 v64, v64
    v_add_f32_e64 v54, v54, v70
    v_fmac_f32_e32 v55, v70, v71
    s_waitcnt lgkmcnt(5)
    v_pk_mul_f16 v170, v154, v170
    v_pk_mul_f16 v171, v155, v171
    v_pk_mul_f16 v172, v156, v172
    v_pk_mul_f16 v173, v157, v173
    v_add_f32_e64 v54, v54, v64
    v_fmac_f32_e64 v55, v64, v65
    v_smfmac_f32_16x16x64_f16 v[82:85], v[14:17], v[166:173], v218
    ds_read_b128 v[62:65], v227 offset:9216
    v_cvt_pk_bf16_f32 v118, |v86|, |v87|
    v_mfma_f32_32x32x16_f16 v[102:117], v[6:9], v[170:173], v[102:117]
    ds_read_b128 v[154:157], v222 offset:12336
    v_cvt_pk_bf16_f32 v120, |v88|, |v89|
    v_cvt_pk_bf16_f32 v122, |v90|, |v91|
    v_cvt_pk_bf16_f32 v124, |v92|, |v93|
    v_cvt_pk_bf16_f32 v126, |v94|, |v95|
    v_cvt_pk_bf16_f32 v128, |v96|, |v97|
    v_cvt_pk_bf16_f32 v130, |v98|, |v99|
    v_cvt_pk_bf16_f32 v132, |v100|, |v101|
    v_pk_mul_f16 v174, v2, v174
    v_pk_mul_f16 v175, v3, v175
    v_pk_mul_f16 v176, v4, v176
    v_pk_mul_f16 v177, v5, v177
    v_pk_mul_f16 v178, v6, v178
    v_pk_mul_f16 v179, v7, v179
    s_waitcnt lgkmcnt(2)
    s_nop 0
    v_mfma_f32_32x32x16_f16 v[86:101], v[174:177], v[142:145], v[22:37]
    ds_read_b128 v[202:205], v222 offset:12352
    v_pk_mul_f16 v180, v8, v180
    v_pk_mul_f16 v181, v9, v181
    v_cvt_pk_bf16_f32 v119, |v102|, |v103|
    v_cvt_pk_bf16_f32 v121, |v104|, |v105|
    v_cvt_pk_bf16_f32 v123, |v106|, |v107|
    v_cvt_pk_bf16_f32 v125, |v108|, |v109|
    v_mfma_f32_32x32x16_f16 v[86:101], v[178:181], v[146:149], v[86:101]
    ds_read_b128 v[166:169], v222 offset:8272
    v_cvt_pk_bf16_f32 v127, |v110|, |v111|
    v_cvt_pk_bf16_f32 v129, |v112|, |v113|
    v_cvt_pk_bf16_f32 v131, |v114|, |v115|
    v_cvt_pk_bf16_f32 v133, |v116|, |v117|
    v_pk_mul_f16 v190, v2, v190
    v_pk_mul_f16 v191, v3, v191
    v_smfmac_f32_16x16x64_bf16 v[82:85], v[40:43], v[118:125], v1
    ds_read_b128 v[170:173], v222 offset:12368
    v_pk_mul_f16 v192, v4, v192
    v_smfmac_f32_16x16x64_bf16 v[82:85], v[48:51], v[126:133], v1
    ds_read_b128 v[78:81], v240 offset:32800
    v_pk_mul_f16 v193, v5, v193
    v_exp_f32_e64 v66, v66
    v_exp_f32_e64 v72, v72
    v_mfma_f32_32x32x16_f16 v[102:117], v[190:193], v[142:145], v[22:37]
    v_add_f32_e64 v54, v54, v66
    v_fmac_f32_e64 v55, v66, v67
    v_pk_mul_f16 v194, v6, v194
    v_pk_mul_f16 v195, v7, v195
    v_pk_mul_f16 v196, v8, v196
    v_pk_mul_f16 v197, v9, v197
    v_add_f32_e64 v54, v54, v72
    v_fmac_f32_e64 v55, v72, v73
    v_mfma_f32_32x32x16_f16 v[102:117], v[194:197], v[146:149], v[102:117]
    ds_read_b128 v[66:69], v227 offset:9472
    v_cvt_pk_bf16_f32 v118, |v86|, |v87|
    v_cvt_pk_bf16_f32 v120, |v88|, |v89|
    v_cvt_pk_bf16_f32 v122, |v90|, |v91|
    v_cvt_pk_bf16_f32 v124, |v92|, |v93|
    v_cvt_pk_bf16_f32 v126, |v94|, |v95|
    v_cvt_pk_bf16_f32 v128, |v96|, |v97|
    v_cvt_pk_bf16_f32 v130, |v98|, |v99|
    v_cvt_pk_bf16_f32 v132, |v100|, |v101|
    v_mfma_f32_32x32x16_f16 v[86:101], v[174:177], v[182:185], v[22:37]
    ds_read_b128 v[70:73], v228 offset:8192
    v_pk_mul_f16 v134, v134, v18
    v_cvt_pk_bf16_f32 v119, |v102|, |v103|
    v_cvt_pk_bf16_f32 v121, |v104|, |v105|
    v_cvt_pk_bf16_f32 v123, |v106|, |v107|
    v_cvt_pk_bf16_f32 v125, |v108|, |v109|
    v_cvt_pk_bf16_f32 v127, |v110|, |v111|
    v_mfma_f32_32x32x16_f16 v[86:101], v[178:181], v[186:189], v[86:101]
    ds_read_b128 v[174:177], v225 offset:8192
    v_cvt_pk_bf16_f32 v129, |v112|, |v113|
    v_cvt_pk_bf16_f32 v131, |v114|, |v115|
    v_cvt_pk_bf16_f32 v133, |v116|, |v117|
    v_pk_mul_f16 v135, v135, v19
    v_pk_mul_f16 v136, v136, v20
    v_pk_mul_f16 v137, v137, v21
    v_mfma_f32_32x32x16_f16 v[102:117], v[190:193], v[182:185], v[22:37]
    ds_read_b128 v[178:181], v225 offset:12288
    v_pk_mul_f16 v138, v138, v18
    v_pk_mul_f16 v139, v139, v19
    v_pk_mul_f16 v140, v140, v20
    v_pk_mul_f16 v141, v141, v21
    v_pk_mul_f16 v158, v2, v158
    v_pk_mul_f16 v159, v3, v159
    v_mfma_f32_16x16x32_f16 v[58:61], v[138:141], v[58:61], 0
    ds_read_b128 v[190:193], v226 offset:8192
    v_pk_mul_f16 v160, v4, v160
    v_pk_mul_f16 v161, v5, v161
    s_waitcnt lgkmcnt(4)
    s_nop 0
    v_mfma_f32_16x16x32_f16 v[62:65], v[134:137], v[62:65], 0
    v_pk_mul_f16 v162, v6, v162
    v_pk_mul_f16 v163, v7, v163
    v_mfma_f32_32x32x16_f16 v[102:117], v[194:197], v[186:189], v[102:117]
    ds_read_b128 v[194:197], v226 offset:12288
    v_pk_mul_f16 v164, v8, v164
    v_pk_mul_f16 v165, v9, v165
    v_pk_mul_f16 v150, v2, v150
    v_pk_mul_f16 v151, v3, v151
    v_pk_mul_f16 v152, v4, v152
    v_pk_mul_f16 v153, v5, v153
    v_smfmac_f32_16x16x64_bf16 v[60:63], v[38:41], v[118:125], v1
    v_cvt_pk_bf16_f32 v118, |v86|, |v87|
    v_smfmac_f32_16x16x64_bf16 v[60:63], v[46:49], v[126:133], v1
    v_cvt_pk_bf16_f32 v120, |v88|, |v89|
    v_mfma_f32_16x16x32_f16 v[66:69], v[138:141], v[66:69], 0
    v_cvt_pk_bf16_f32 v122, |v90|, |v91|
    v_cvt_pk_bf16_f32 v124, |v92|, |v93|
    s_waitcnt lgkmcnt(3)
    s_nop 0
    v_mfma_f32_16x16x32_f16 v[70:73], v[134:137], v[70:73], 0
    v_cvt_pk_bf16_f32 v126, |v94|, |v95|
    v_cvt_pk_bf16_f32 v128, |v96|, |v97|
    v_cvt_pk_bf16_f32 v130, |v98|, |v99|
    v_cvt_pk_bf16_f32 v132, |v100|, |v101|
    s_waitcnt lgkmcnt(2)
    v_mfma_f32_32x32x16_f16 v[86:101], v[158:161], v[142:145], v[22:37]
    s_waitcnt vmcnt(0)
    v_cvt_pk_bf16_f32 v119, |v102|, |v103|
    v_cvt_pk_bf16_f32 v121, |v104|, |v105|
    v_cvt_pk_bf16_f32 v123, |v106|, |v107|
    v_cvt_pk_bf16_f32 v125, |v108|, |v109|
    v_cvt_pk_bf16_f32 v127, |v110|, |v111|
    v_cvt_pk_bf16_f32 v129, |v112|, |v113|
    v_smfmac_f32_16x16x64_bf16 v[68:71], v[38:41], v[118:125], v1
    v_cvt_pk_bf16_f32 v131, |v114|, |v115|
    v_mfma_f32_32x32x16_f16 v[86:101], v[162:165], v[146:149], v[86:101]
    v_cvt_pk_bf16_f32 v133, |v116|, |v117|
    v_pk_mul_f16 v154, v6, v154
    v_pk_mul_f16 v155, v7, v155
    v_pk_mul_f16 v156, v8, v156
    v_pk_mul_f16 v157, v9, v157
    v_lshlrev_b32_e64 v220, 16, v210
    v_smfmac_f32_16x16x64_bf16 v[68:71], v[46:49], v[126:133], v1
    v_and_b32_e64 v210, s32, v210
    v_mfma_f32_32x32x16_f16 v[102:117], v[150:153], v[142:145], v[22:37]
    ds_read_b128 v[142:145], v222 offset:8288
    v_lshlrev_b32_e64 v221, 16, v211
    v_max3_f32 v219, |v220|, |v210|, v219
    v_cvt_pk_bf16_f32 v118, |v86|, |v87|
    v_cvt_pk_bf16_f32 v120, |v88|, |v89|
    v_cvt_pk_bf16_f32 v122, |v90|, |v91|
    v_cvt_pk_bf16_f32 v124, |v92|, |v93|
    v_mfma_f32_32x32x16_f16 v[102:117], v[154:157], v[146:149], v[102:117]
    ds_read_b128 v[146:149], v222 offset:12384
    v_cvt_pk_bf16_f32 v126, |v94|, |v95|
    v_cvt_pk_bf16_f32 v128, |v96|, |v97|
    v_cvt_pk_bf16_f32 v130, |v98|, |v99|
    v_cvt_pk_bf16_f32 v132, |v100|, |v101|
    v_and_b32_e64 v211, s32, v211
    v_cmp_le_f32 s[34:35], s40, |v220|
    s_waitcnt lgkmcnt(2)
    s_setprio 0
    v_mfma_f32_32x32x16_f16 v[86:101], v[158:161], v[182:185], v[22:37]
    ds_read_b128 v[158:161], v222 offset:8304
    s_cmp_eq_u64 s[34:35], 0
    v_cvt_pk_f16_f32 v210, v220, v210
    s_cselect_b32 s33, s41, s33
    v_max3_f32 v219, |v221|, |v211|, v219
    v_cvt_pk_f16_f32 v211, v221, v211
    v_lshlrev_b32_e64 v220, 16, v212
    v_and_b32_e64 v212, s32, v212
    v_mfma_f32_32x32x16_f16 v[86:101], v[162:165], v[186:189], v[86:101]
    ds_read_b128 v[162:165], v222 offset:12400
    v_lshlrev_b32_e64 v221, 16, v213
    v_cvt_pk_bf16_f32 v119, |v102|, |v103|
    v_cvt_pk_bf16_f32 v121, |v104|, |v105|
    v_cvt_pk_bf16_f32 v123, |v106|, |v107|
    v_cvt_pk_bf16_f32 v125, |v108|, |v109|
    v_cvt_pk_bf16_f32 v127, |v110|, |v111|
    v_cvt_pk_bf16_f32 v129, |v112|, |v113|
    v_smfmac_f32_16x16x64_bf16 v[60:63], v[42:45], v[118:125], v1
    v_cvt_pk_bf16_f32 v131, |v114|, |v115|
    v_cvt_pk_bf16_f32 v133, |v116|, |v117|
    v_max3_f32 v219, |v220|, |v212|, v219
    v_and_b32_e64 v213, s32, v213
    v_smfmac_f32_16x16x64_bf16 v[60:63], v[50:53], v[126:133], v1
    v_cvt_pk_f16_f32 v212, v220, v212
    v_mfma_f32_32x32x16_f16 v[102:117], v[150:153], v[182:185], v[22:37]
    v_max3_f32 v219, |v221|, |v213|, v219
    v_cvt_pk_f16_f32 v213, v221, v213
    v_lshlrev_b32_e64 v220, 16, v214
    v_and_b32_e64 v214, s32, v214
    v_lshlrev_b32_e64 v221, 16, v215
    v_max3_f32 v219, |v220|, |v214|, v219
    v_and_b32_e64 v215, s32, v215
    v_cmp_le_f32 s[34:35], s40, |v220|
    v_cvt_pk_f16_f32 v214, v220, v214
    v_max3_f32 v219, |v221|, |v215|, v219
    s_cmp_eq_u64 s[34:35], 0
    v_mfma_f32_32x32x16_f16 v[102:117], v[154:157], v[186:189], v[102:117]
    s_cselect_b32 s33, s41, s33
    v_cvt_pk_f16_f32 v215, v221, v215
    v_lshlrev_b32_e64 v220, 16, v216
    v_and_b32_e64 v216, s32, v216
    v_lshlrev_b32_e64 v221, 16, v217
    v_max3_f32 v219, |v220|, |v216|, v219
    v_and_b32_e64 v217, s32, v217
    v_max3_f32 v219, |v221|, |v217|, v219
    v_cvt_pk_bf16_f32 v118, |v86|, |v87|
    v_cvt_pk_bf16_f32 v120, |v88|, |v89|
    v_cvt_pk_bf16_f32 v122, |v90|, |v91|
    v_cvt_pk_bf16_f32 v124, |v92|, |v93|
    v_cvt_pk_bf16_f32 v126, |v94|, |v95|
    v_cvt_pk_bf16_f32 v128, |v96|, |v97|
    v_cvt_pk_bf16_f32 v130, |v98|, |v99|
    v_cvt_pk_bf16_f32 v132, |v100|, |v101|
    v_pk_mul_f16 v198, v2, v198
    v_pk_mul_f16 v199, v3, v199
    v_pk_mul_f16 v200, v4, v200
    v_pk_mul_f16 v201, v5, v201
    v_cvt_pk_f16_f32 v216, v220, v216
    v_cvt_pk_f16_f32 v217, v221, v217
    s_waitcnt lgkmcnt(0)
    s_nop 0
    v_mfma_f32_32x32x16_f16 v[86:101], v[198:201], v[174:177], v[22:37]
    ds_write_b128 v241, v[210:213] offset:16384
    v_pk_mul_f16 v202, v6, v202
    v_pk_mul_f16 v203, v7, v203
    v_pk_mul_f16 v204, v8, v204
    v_pk_mul_f16 v205, v9, v205
    v_cvt_pk_bf16_f32 v119, |v102|, |v103|
    v_cvt_pk_bf16_f32 v121, |v104|, |v105|
    v_mfma_f32_32x32x16_f16 v[86:101], v[202:205], v[178:181], v[86:101]
    ds_write_b128 v241, v[214:217] offset:24576
    v_cvt_pk_bf16_f32 v123, |v106|, |v107|
    v_cvt_pk_bf16_f32 v125, |v108|, |v109|
    v_cvt_pk_bf16_f32 v127, |v110|, |v111|
    v_cvt_pk_bf16_f32 v129, |v112|, |v113|
    v_cvt_pk_bf16_f32 v131, |v114|, |v115|
    v_cvt_pk_bf16_f32 v133, |v116|, |v117|
    v_smfmac_f32_16x16x64_bf16 v[68:71], v[42:45], v[118:125], v1
    v_pk_mul_f16 v166, v2, v166
    v_smfmac_f32_16x16x64_bf16 v[68:71], v[50:53], v[126:133], v1
    v_pk_mul_f16 v167, v3, v167
    v_pk_mul_f16 v168, v4, v168
    v_pk_mul_f16 v169, v5, v169
    v_exp_f32_e64 v74, v74
    v_pk_mul_f16 v170, v6, v170
    v_mfma_f32_32x32x16_f16 v[102:117], v[166:169], v[174:177], v[22:37]
    v_pk_mul_f16 v171, v7, v171
    v_pk_mul_f16 v172, v8, v172
    v_pk_mul_f16 v173, v9, v173
    v_add_f32_e64 v54, v54, v74
    v_fmac_f32_e64 v55, v74, v75
    v_max_f32_e64 v219, s33, v219
    v_mfma_f32_32x32x16_f16 v[102:117], v[170:173], v[178:181], v[102:117]
    ds_read_b128 v[74:77], v230 offset:8192
    v_cvt_pk_bf16_f32 v118, |v86|, |v87|
    v_cvt_pk_bf16_f32 v120, |v88|, |v89|
    v_cvt_pk_bf16_f32 v122, |v90|, |v91|
    v_cvt_pk_bf16_f32 v124, |v92|, |v93|
    v_cvt_pk_bf16_f32 v126, |v94|, |v95|
    v_cvt_pk_bf16_f32 v128, |v96|, |v97|
    v_cvt_pk_bf16_f32 v130, |v98|, |v99|
    v_cvt_pk_bf16_f32 v132, |v100|, |v101|
    v_mfma_f32_32x32x16_f16 v[86:101], v[198:201], v[190:193], v[22:37]
    s_waitcnt lgkmcnt(1)
    s_barrier
    v_pk_mul_f16 v142, v2, v142
    v_cvt_pk_bf16_f32 v119, |v102|, |v103|
    v_cvt_pk_bf16_f32 v121, |v104|, |v105|
    v_cvt_pk_bf16_f32 v123, |v106|, |v107|
    v_cvt_pk_bf16_f32 v125, |v108|, |v109|
    v_cvt_pk_bf16_f32 v127, |v110|, |v111|
    v_mfma_f32_32x32x16_f16 v[86:101], v[202:205], v[194:197], v[86:101]
    ds_max_u32 v244, v219 offset:9216
    v_cvt_pk_bf16_f32 v129, |v112|, |v113|
    v_cvt_pk_bf16_f32 v131, |v114|, |v115|
    v_cvt_pk_bf16_f32 v133, |v116|, |v117|
    v_pk_mul_f16 v143, v3, v143
    v_pk_mul_f16 v144, v4, v144
    v_pk_mul_f16 v145, v5, v145
    v_smfmac_f32_16x16x64_bf16 v[64:67], v[38:41], v[118:125], v1
    ds_read_b128 v[150:153], v238 offset:0
    v_pk_mul_f16 v146, v6, v146
    v_smfmac_f32_16x16x64_bf16 v[64:67], v[46:49], v[126:133], v1
    ds_read_b128 v[182:185], v239 offset:0
    v_cvt_pk_bf16_f32 v118, |v86|, |v87|
    s_cbranch_vccz 1
    s_setprio 1
    v_mfma_f32_32x32x16_f16 v[102:117], v[166:169], v[190:193], v[22:37]
    ds_read_b128 v[154:157], v238 offset:4096
    v_cvt_pk_bf16_f32 v120, |v88|, |v89|
    v_cvt_pk_bf16_f32 v122, |v90|, |v91|
    v_cvt_pk_bf16_f32 v124, |v92|, |v93|
    v_cvt_pk_bf16_f32 v126, |v94|, |v95|
    v_cvt_pk_bf16_f32 v128, |v96|, |v97|
    v_cvt_pk_bf16_f32 v130, |v98|, |v99|
    v_mfma_f32_32x32x16_f16 v[102:117], v[170:173], v[194:197], v[102:117]
    ds_read_b128 v[186:189], v239 offset:4096
    v_cvt_pk_bf16_f32 v132, |v100|, |v101|
    v_pk_mul_f16 v147, v7, v147
    v_pk_mul_f16 v148, v8, v148
    v_pk_mul_f16 v149, v9, v149
    v_pk_mul_f16 v158, v2, v158
    v_pk_mul_f16 v159, v3, v159
    s_waitcnt lgkmcnt(4)
    s_nop 0
    v_mfma_f32_16x16x32_f16 v[74:77], v[138:141], v[74:77], 0
    ds_read_b128 v[198:201], v239 offset:16
    v_pk_mul_f16 v160, v4, v160
    v_pk_mul_f16 v161, v5, v161
    v_mfma_f32_32x32x16_f16 v[86:101], v[142:145], v[174:177], v[22:37]
    ds_read_b128 v[202:205], v239 offset:4112
    v_cvt_pk_bf16_f32 v119, |v102|, |v103|
    v_cvt_pk_bf16_f32 v121, |v104|, |v105|
    v_cvt_pk_bf16_f32 v123, |v106|, |v107|
    v_cvt_pk_bf16_f32 v125, |v108|, |v109|
    v_cvt_pk_bf16_f32 v127, |v110|, |v111|
    v_cvt_pk_bf16_f32 v129, |v112|, |v113|
    v_smfmac_f32_16x16x64_bf16 v[72:75], v[38:41], v[118:125], v1
    ds_read_b128 v[166:169], v234 offset:16384
    v_cvt_pk_bf16_f32 v131, |v114|, |v115|
    v_mfma_f32_32x32x16_f16 v[86:101], v[146:149], v[178:181], v[86:101]
    ds_read_b128 v[170:173], v234 offset:20480
    v_cvt_pk_bf16_f32 v133, |v116|, |v117|
    v_pk_mul_f16 v162, v6, v162
    v_pk_mul_f16 v163, v7, v163
    v_pk_mul_f16 v164, v8, v164
    v_pk_mul_f16 v165, v9, v165
    v_add_f32_e64 v82, v82, v84
    v_smfmac_f32_16x16x64_bf16 v[72:75], v[46:49], v[126:133], v1
    ds_write_b64 v242, v[54:55] offset:0
    v_exp_f32_e64 v54, v82
    v_mfma_f32_32x32x16_f16 v[102:117], v[158:161], v[174:177], v[22:37]
    ds_read_b128 v[174:177], v235 offset:16384
    v_cvt_pk_bf16_f32 v118, |v86|, |v87|
    v_cvt_pk_bf16_f32 v120, |v88|, |v89|
    v_cvt_pk_bf16_f32 v122, |v90|, |v91|
    v_cvt_pk_bf16_f32 v124, |v92|, |v93|
    v_cvt_pk_bf16_f32 v126, |v94|, |v95|
    v_cvt_pk_bf16_f32 v128, |v96|, |v97|
    v_mfma_f32_32x32x16_f16 v[102:117], v[162:165], v[178:181], v[102:117]
    ds_read_b128 v[178:181], v235 offset:20480
    v_cvt_pk_bf16_f32 v130, |v98|, |v99|
    v_cvt_pk_bf16_f32 v132, |v100|, |v101|
    s_waitcnt lgkmcnt(5)
    s_nop 0
    v_pk_mul_f16 v182, v150, v182
    v_pk_mul_f16 v183, v151, v183
    v_pk_mul_f16 v184, v152, v184
    v_pk_mul_f16 v185, v153, v185
    v_mfma_f32_32x32x16_f16 v[86:101], v[142:145], v[190:193], v[22:37]
    ds_read_b128 v[142:145], v236 offset:16384
    v_pk_mul_f16 v186, v154, v186
    v_pk_mul_f16 v187, v155, v187
    v_pk_mul_f16 v188, v156, v188
    v_cvt_pk_bf16_f32 v119, |v102|, |v103|
    v_cvt_pk_bf16_f32 v121, |v104|, |v105|
    v_cvt_pk_bf16_f32 v123, |v106|, |v107|
    v_mfma_f32_32x32x16_f16 v[86:101], v[146:149], v[194:197], v[86:101]
    ds_read_b128 v[146:149], v236 offset:20480
    v_cvt_pk_bf16_f32 v125, |v108|, |v109|
    v_cvt_pk_bf16_f32 v127, |v110|, |v111|
    v_cvt_pk_bf16_f32 v129, |v112|, |v113|
    v_cvt_pk_bf16_f32 v131, |v114|, |v115|
    v_cvt_pk_bf16_f32 v133, |v116|, |v117|
    v_pk_mul_f16 v189, v157, v189
    v_smfmac_f32_16x16x64_bf16 v[64:67], v[42:45], v[118:125], v1
    ds_read_b128 v[134:137], v231 offset:16384
    v_pk_mul_f16 v198, v150, v198
    v_smfmac_f32_16x16x64_bf16 v[64:67], v[50:53], v[126:133], v1
    ds_read_b128 v[138:141], v232 offset:16384
    v_cvt_pk_bf16_f32 v118, |v86|, |v87|
    v_smfmac_f32_16x16x64_f16 v[78:81], v[10:13], v[182:189], v218
    v_cvt_pk_bf16_f32 v120, |v88|, |v89|
    v_mfma_f32_32x32x16_f16 v[102:117], v[158:161], v[190:193], v[22:37]
    ds_read_b128 v[158:161], v237 offset:16384
    v_cvt_pk_bf16_f32 v122, |v90|, |v91|
    v_cvt_pk_bf16_f32 v124, |v92|, |v93|
    v_cvt_pk_bf16_f32 v126, |v94|, |v95|
    v_cvt_pk_bf16_f32 v128, |v96|, |v97|
    v_cvt_pk_bf16_f32 v130, |v98|, |v99|
    v_cvt_pk_bf16_f32 v132, |v100|, |v101|
    v_mfma_f32_32x32x16_f16 v[102:117], v[162:165], v[194:197], v[102:117]
    ds_read_b128 v[162:165], v237 offset:20480
    v_pk_mul_f16 v199, v151, v199
    v_pk_mul_f16 v200, v152, v200
    v_pk_mul_f16 v201, v153, v201
    v_pk_mul_f16 v202, v154, v202
    v_pk_mul_f16 v203, v155, v203
    v_pk_mul_f16 v204, v156, v204
    s_waitcnt lgkmcnt(4)
    v_mfma_f32_32x32x16_f16 v[86:101], v[2:5], v[182:185], v[22:37]
    ds_read_b128 v[190:193], v222 offset:16384
    v_pk_mul_f16 v205, v157, v205
    v_add_f32_e32 v83, v83, v85
    v_mul_f32_e64 v55, v54, v83
    v_cvt_pk_bf16_f32 v119, |v102|, |v103|
    v_cvt_pk_bf16_f32 v121, |v104|, |v105|
    v_cvt_pk_bf16_f32 v123, |v106|, |v107|
    v_smfmac_f32_16x16x64_f16 v[78:81], v[14:17], v[198:205], v218
    ds_read_b128 v[182:185], v223 offset:16384
    v_cvt_pk_bf16_f32 v125, |v108|, |v109|
    v_mfma_f32_32x32x16_f16 v[86:101], v[6:9], v[186:189], v[86:101]
    ds_read_b128 v[194:197], v222 offset:20480
    v_cvt_pk_bf16_f32 v127, |v110|, |v111|
    v_cvt_pk_bf16_f32 v129, |v112|, |v113|
    v_cvt_pk_bf16_f32 v131, |v114|, |v115|
    v_cvt_pk_bf16_f32 v133, |v116|, |v117|
    v_pk_mul_f16 v174, v166, v174
    v_pk_mul_f16 v175, v167, v175
    v_smfmac_f32_16x16x64_bf16 v[72:75], v[42:45], v[118:125], v1
    ds_read_b128 v[186:189], v223 offset:20480
    v_pk_mul_f16 v176, v168, v176
    v_smfmac_f32_16x16x64_bf16 v[72:75], v[50:53], v[126:133], v1
    ds_read_b128 v[150:153], v222 offset:16400
    v_cvt_pk_bf16_f32 v118, |v86|, |v87|
    v_mfma_f32_32x32x16_f16 v[102:117], v[2:5], v[198:201], v[22:37]
    ds_read_b128 v[82:85], v240 offset:32768
    v_cvt_pk_bf16_f32 v120, |v88|, |v89|
    v_cvt_pk_bf16_f32 v122, |v90|, |v91|
    v_cvt_pk_bf16_f32 v124, |v92|, |v93|
    v_cvt_pk_bf16_f32 v126, |v94|, |v95|
    v_cvt_pk_bf16_f32 v128, |v96|, |v97|
    v_cvt_pk_bf16_f32 v130, |v98|, |v99|
    v_mfma_f32_32x32x16_f16 v[102:117], v[6:9], v[202:205], v[102:117]
    ds_read_b128 v[154:157], v222 offset:20496
    v_cvt_pk_bf16_f32 v132, |v100|, |v101|
    v_pk_mul_f16 v177, v169, v177
    v_pk_mul_f16 v178, v170, v178
    v_pk_mul_f16 v179, v171, v179
    v_pk_mul_f16 v180, v172, v180
    v_pk_mul_f16 v181, v173, v181
    v_mfma_f32_32x32x16_f16 v[86:101], v[2:5], v[174:177], v[22:37]
    ds_read_b128 v[198:201], v224 offset:16384
    s_waitcnt lgkmcnt(5)
    s_nop 0
    v_pk_mul_f16 v158, v142, v158
    v_pk_mul_f16 v159, v143, v159
    v_pk_mul_f16 v160, v144, v160
    v_cvt_pk_bf16_f32 v119, |v102|, |v103|
    v_cvt_pk_bf16_f32 v121, |v104|, |v105|
    v_cvt_pk_bf16_f32 v123, |v106|, |v107|
    v_mfma_f32_32x32x16_f16 v[86:101], v[6:9], v[178:181], v[86:101]
    ds_read_b128 v[202:205], v224 offset:20480
    v_cvt_pk_bf16_f32 v125, |v108|, |v109|
    v_cvt_pk_bf16_f32 v127, |v110|, |v111|
    v_cvt_pk_bf16_f32 v129, |v112|, |v113|
    v_cvt_pk_bf16_f32 v131, |v114|, |v115|
    v_cvt_pk_bf16_f32 v133, |v116|, |v117|
    v_pk_mul_f16 v161, v145, v161
    v_smfmac_f32_16x16x64_bf16 v[78:81], v[40:43], v[118:125], v1
    ds_read_b128 v[166:169], v222 offset:16416
    v_exp_f32_e64 v60, v60
    v_smfmac_f32_16x16x64_bf16 v[78:81], v[48:51], v[126:133], v1
    ds_read_b128 v[170:173], v222 offset:20512
    v_exp_f32_e64 v62, v62
    v_mfma_f32_32x32x16_f16 v[102:117], v[2:5], v[158:161], v[22:37]
    ds_read_b128 v[142:145], v222 offset:16432
    v_add_f32_e64 v54, v54, v60
    v_fmac_f32_e64 v55, v60, v61
    v_exp_f32_e64 v68, v68
    v_add_f32_e64 v54, v54, v62
    v_fmac_f32_e32 v55, v62, v63
    s_waitcnt lgkmcnt(5)
    v_smfmac_f32_16x16x64_f16 v[82:85], v[10:13], v[174:181], v218
    ds_read_b128 v[58:61], v229 offset:16384
    v_exp_f32_e64 v70, v70
    v_add_f32_e64 v54, v54, v68
    v_fmac_f32_e64 v55, v68, v69
    v_exp_f32_e64 v64, v64
    v_add_f32_e64 v54, v54, v70
    v_fmac_f32_e64 v55, v70, v71
    v_pk_mul_f16 v162, v146, v162
    v_pk_mul_f16 v163, v147, v163
    v_pk_mul_f16 v164, v148, v164
    v_pk_mul_f16 v165, v149, v165
    v_add_f32_e64 v54, v54, v64
    v_fmac_f32_e64 v55, v64, v65
    v_smfmac_f32_16x16x64_f16 v[82:85], v[14:17], v[158:165], v218
    ds_read_b128 v[62:65], v227 offset:17408
    v_cvt_pk_bf16_f32 v118, |v86|, |v87|
    v_mfma_f32_32x32x16_f16 v[102:117], v[6:9], v[162:165], v[102:117]
    ds_read_b128 v[146:149], v222 offset:20528
    v_cvt_pk_bf16_f32 v120, |v88|, |v89|
    v_cvt_pk_bf16_f32 v122, |v90|, |v91|
    v_cvt_pk_bf16_f32 v124, |v92|, |v93|
    v_cvt_pk_bf16_f32 v126, |v94|, |v95|
    v_cvt_pk_bf16_f32 v128, |v96|, |v97|
    v_cvt_pk_bf16_f32 v130, |v98|, |v99|
    v_cvt_pk_bf16_f32 v132, |v100|, |v101|
    v_pk_mul_f16 v190, v2, v190
    v_pk_mul_f16 v191, v3, v191
    v_pk_mul_f16 v192, v4, v192
    v_pk_mul_f16 v193, v5, v193
    v_pk_mul_f16 v194, v6, v194
    v_pk_mul_f16 v195, v7, v195
    s_waitcnt lgkmcnt(2)
    s_nop 0
    v_mfma_f32_32x32x16_f16 v[86:101], v[190:193], v[182:185], v[22:37]
    ds_read_b128 v[174:177], v222 offset:16448
    v_pk_mul_f16 v196, v8, v196
    v_pk_mul_f16 v197, v9, v197
    v_cvt_pk_bf16_f32 v119, |v102|, |v103|
    v_cvt_pk_bf16_f32 v121, |v104|, |v105|
    v_cvt_pk_bf16_f32 v123, |v106|, |v107|
    v_cvt_pk_bf16_f32 v125, |v108|, |v109|
    v_mfma_f32_32x32x16_f16 v[86:101], v[194:197], v[186:189], v[86:101]
    ds_read_b128 v[178:181], v222 offset:20544
    v_cvt_pk_bf16_f32 v127, |v110|, |v111|
    v_cvt_pk_bf16_f32 v129, |v112|, |v113|
    v_cvt_pk_bf16_f32 v131, |v114|, |v115|
    v_cvt_pk_bf16_f32 v133, |v116|, |v117|
    v_pk_mul_f16 v150, v2, v150
    v_pk_mul_f16 v151, v3, v151
    v_smfmac_f32_16x16x64_bf16 v[82:85], v[40:43], v[118:125], v1
    ds_read_b128 v[158:161], v222 offset:16464
    v_pk_mul_f16 v152, v4, v152
    v_smfmac_f32_16x16x64_bf16 v[82:85], v[48:51], v[126:133], v1
    ds_read_b128 v[162:165], v222 offset:20560
    v_pk_mul_f16 v153, v5, v153
    v_exp_f32_e64 v66, v66
    v_exp_f32_e64 v72, v72
    v_mfma_f32_32x32x16_f16 v[102:117], v[150:153], v[182:185], v[22:37]
    v_add_f32_e64 v54, v54, v66
    v_fmac_f32_e64 v55, v66, v67
    v_pk_mul_f16 v154, v6, v154
    v_pk_mul_f16 v155, v7, v155
    v_pk_mul_f16 v156, v8, v156
    v_pk_mul_f16 v157, v9, v157
    v_add_f32_e64 v54, v54, v72
    v_fmac_f32_e64 v55, v72, v73
    v_mfma_f32_32x32x16_f16 v[102:117], v[154:157], v[186:189], v[102:117]
    ds_read_b128 v[66:69], v227 offset:17664
    v_cvt_pk_bf16_f32 v118, |v86|, |v87|
    v_cvt_pk_bf16_f32 v120, |v88|, |v89|
    v_cvt_pk_bf16_f32 v122, |v90|, |v91|
    v_cvt_pk_bf16_f32 v124, |v92|, |v93|
    v_cvt_pk_bf16_f32 v126, |v94|, |v95|
    v_cvt_pk_bf16_f32 v128, |v96|, |v97|
    v_cvt_pk_bf16_f32 v130, |v98|, |v99|
    v_cvt_pk_bf16_f32 v132, |v100|, |v101|
    v_mfma_f32_32x32x16_f16 v[86:101], v[190:193], v[198:201], v[22:37]
    ds_read_b128 v[70:73], v228 offset:16384
    v_pk_mul_f16 v134, v134, v18
    v_cvt_pk_bf16_f32 v119, |v102|, |v103|
    v_cvt_pk_bf16_f32 v121, |v104|, |v105|
    v_cvt_pk_bf16_f32 v123, |v106|, |v107|
    v_cvt_pk_bf16_f32 v125, |v108|, |v109|
    v_cvt_pk_bf16_f32 v127, |v110|, |v111|
    v_mfma_f32_32x32x16_f16 v[86:101], v[194:197], v[202:205], v[86:101]
    ds_read_b128 v[190:193], v225 offset:16384
    v_cvt_pk_bf16_f32 v129, |v112|, |v113|
    v_cvt_pk_bf16_f32 v131, |v114|, |v115|
    v_cvt_pk_bf16_f32 v133, |v116|, |v117|
    v_pk_mul_f16 v135, v135, v19
    v_pk_mul_f16 v136, v136, v20
    v_pk_mul_f16 v137, v137, v21
    v_mfma_f32_32x32x16_f16 v[102:117], v[150:153], v[198:201], v[22:37]
    ds_read_b128 v[194:197], v225 offset:20480
    v_pk_mul_f16 v138, v138, v18
    v_pk_mul_f16 v139, v139, v19
    v_pk_mul_f16 v140, v140, v20
    v_pk_mul_f16 v141, v141, v21
    v_pk_mul_f16 v166, v2, v166
    v_pk_mul_f16 v167, v3, v167
    v_mfma_f32_16x16x32_f16 v[58:61], v[138:141], v[58:61], 0
    ds_read_b128 v[150:153], v226 offset:16384
    v_pk_mul_f16 v168, v4, v168
    v_pk_mul_f16 v169, v5, v169
    s_waitcnt lgkmcnt(4)
    s_nop 0
    v_mfma_f32_16x16x32_f16 v[62:65], v[134:137], v[62:65], 0
    v_pk_mul_f16 v170, v6, v170
    v_pk_mul_f16 v171, v7, v171
    v_mfma_f32_32x32x16_f16 v[102:117], v[154:157], v[202:205], v[102:117]
    ds_read_b128 v[154:157], v226 offset:20480
    v_pk_mul_f16 v172, v8, v172
    v_pk_mul_f16 v173, v9, v173
    v_pk_mul_f16 v142, v2, v142
    v_pk_mul_f16 v143, v3, v143
    v_pk_mul_f16 v144, v4, v144
    v_pk_mul_f16 v145, v5, v145
    v_smfmac_f32_16x16x64_bf16 v[60:63], v[38:41], v[118:125], v1
    v_cvt_pk_bf16_f32 v118, |v86|, |v87|
    v_smfmac_f32_16x16x64_bf16 v[60:63], v[46:49], v[126:133], v1
    v_cvt_pk_bf16_f32 v120, |v88|, |v89|
    v_mfma_f32_16x16x32_f16 v[66:69], v[138:141], v[66:69], 0
    v_cvt_pk_bf16_f32 v122, |v90|, |v91|
    v_cvt_pk_bf16_f32 v124, |v92|, |v93|
    s_waitcnt lgkmcnt(3)
    s_nop 0
    v_mfma_f32_16x16x32_f16 v[70:73], v[134:137], v[70:73], 0
    ds_read_b128 v[134:137], v231 offset:24576
    v_cvt_pk_bf16_f32 v126, |v94|, |v95|
    v_cvt_pk_bf16_f32 v128, |v96|, |v97|
    v_cvt_pk_bf16_f32 v130, |v98|, |v99|
    v_cvt_pk_bf16_f32 v132, |v100|, |v101|
    s_waitcnt lgkmcnt(3)
    s_nop 0
    v_mfma_f32_32x32x16_f16 v[86:101], v[166:169], v[182:185], v[22:37]
    v_cvt_pk_bf16_f32 v119, |v102|, |v103|
    v_cvt_pk_bf16_f32 v121, |v104|, |v105|
    v_cvt_pk_bf16_f32 v123, |v106|, |v107|
    v_cvt_pk_bf16_f32 v125, |v108|, |v109|
    v_cvt_pk_bf16_f32 v127, |v110|, |v111|
    v_cvt_pk_bf16_f32 v129, |v112|, |v113|
    v_smfmac_f32_16x16x64_bf16 v[68:71], v[38:41], v[118:125], v1
    v_cvt_pk_bf16_f32 v131, |v114|, |v115|
    v_mfma_f32_32x32x16_f16 v[86:101], v[170:173], v[186:189], v[86:101]
    v_cvt_pk_bf16_f32 v133, |v116|, |v117|
    v_pk_mul_f16 v146, v6, v146
    v_pk_mul_f16 v147, v7, v147
    v_pk_mul_f16 v148, v8, v148
    v_pk_mul_f16 v149, v9, v149
    v_pk_mul_f16 v174, v2, v174
    v_smfmac_f32_16x16x64_bf16 v[68:71], v[46:49], v[126:133], v1
    v_pk_mul_f16 v175, v3, v175
    v_mfma_f32_32x32x16_f16 v[102:117], v[142:145], v[182:185], v[22:37]
    ds_read_b128 v[182:185], v222 offset:16480
    v_pk_mul_f16 v176, v4, v176
    v_pk_mul_f16 v177, v5, v177
    v_cvt_pk_bf16_f32 v118, |v86|, |v87|
    v_cvt_pk_bf16_f32 v120, |v88|, |v89|
    v_cvt_pk_bf16_f32 v122, |v90|, |v91|
    v_cvt_pk_bf16_f32 v124, |v92|, |v93|
    v_mfma_f32_32x32x16_f16 v[102:117], v[146:149], v[186:189], v[102:117]
    ds_read_b128 v[186:189], v222 offset:20576
    v_cvt_pk_bf16_f32 v126, |v94|, |v95|
    v_cvt_pk_bf16_f32 v128, |v96|, |v97|
    v_cvt_pk_bf16_f32 v130, |v98|, |v99|
    v_cvt_pk_bf16_f32 v132, |v100|, |v101|
    v_pk_mul_f16 v178, v6, v178
    v_pk_mul_f16 v179, v7, v179
    v_mfma_f32_32x32x16_f16 v[86:101], v[166:169], v[198:201], v[22:37]
    ds_read_b128 v[166:169], v222 offset:16496
    v_pk_mul_f16 v180, v8, v180
    v_pk_mul_f16 v181, v9, v181
    v_pk_mul_f16 v158, v2, v158
    v_cvt_pk_bf16_f32 v119, |v102|, |v103|
    v_cvt_pk_bf16_f32 v121, |v104|, |v105|
    v_cvt_pk_bf16_f32 v123, |v106|, |v107|
    v_mfma_f32_32x32x16_f16 v[86:101], v[170:173], v[202:205], v[86:101]
    ds_read_b128 v[170:173], v222 offset:20592
    v_cvt_pk_bf16_f32 v125, |v108|, |v109|
    v_cvt_pk_bf16_f32 v127, |v110|, |v111|
    v_cvt_pk_bf16_f32 v129, |v112|, |v113|
    v_cvt_pk_bf16_f32 v131, |v114|, |v115|
    v_cvt_pk_bf16_f32 v133, |v116|, |v117|
    v_pk_mul_f16 v159, v3, v159
    v_smfmac_f32_16x16x64_bf16 v[60:63], v[42:45], v[118:125], v1
    v_pk_mul_f16 v160, v4, v160
    v_smfmac_f32_16x16x64_bf16 v[60:63], v[50:53], v[126:133], v1
    v_pk_mul_f16 v161, v5, v161
    v_mfma_f32_32x32x16_f16 v[102:117], v[142:145], v[198:201], v[22:37]
    ds_read_b128 v[142:145], v238 offset:0
    v_cvt_pk_bf16_f32 v118, |v86|, |v87|
    v_cvt_pk_bf16_f32 v120, |v88|, |v89|
    v_cvt_pk_bf16_f32 v122, |v90|, |v91|
    v_cvt_pk_bf16_f32 v124, |v92|, |v93|
    v_cvt_pk_bf16_f32 v126, |v94|, |v95|
    v_cvt_pk_bf16_f32 v128, |v96|, |v97|
    v_mfma_f32_32x32x16_f16 v[102:117], v[146:149], v[202:205], v[102:117]
    ds_read_b128 v[198:201], v239 offset:32
    v_cvt_pk_bf16_f32 v130, |v98|, |v99|
    v_cvt_pk_bf16_f32 v132, |v100|, |v101|
    v_exp_f32_e64 v74, v74
    v_pk_mul_f16 v162, v6, v162
    v_pk_mul_f16 v163, v7, v163
    s_waitcnt lgkmcnt(3)
    s_nop 0
    v_mfma_f32_32x32x16_f16 v[86:101], v[174:177], v[190:193], v[22:37]
    ds_read_b128 v[146:149], v238 offset:4096
    v_pk_mul_f16 v164, v8, v164
    v_pk_mul_f16 v165, v9, v165
    v_add_f32_e64 v54, v54, v74
    v_fmac_f32_e64 v55, v74, v75
    v_cvt_pk_bf16_f32 v119, |v102|, |v103|
    v_cvt_pk_bf16_f32 v121, |v104|, |v105|
    v_mfma_f32_32x32x16_f16 v[86:101], v[178:181], v[194:197], v[86:101]
    ds_read_b128 v[74:77], v230 offset:16384
    v_cvt_pk_bf16_f32 v123, |v106|, |v107|
    v_cvt_pk_bf16_f32 v125, |v108|, |v109|
    v_cvt_pk_bf16_f32 v127, |v110|, |v111|
    v_cvt_pk_bf16_f32 v129, |v112|, |v113|
    v_cvt_pk_bf16_f32 v131, |v114|, |v115|
    v_cvt_pk_bf16_f32 v133, |v116|, |v117|
    v_smfmac_f32_16x16x64_bf16 v[68:71], v[42:45], v[118:125], v1
    ds_read_b128 v[202:205], v239 offset:4128
    v_pk_mul_f16 v182, v2, v182
    v_smfmac_f32_16x16x64_bf16 v[68:71], v[50:53], v[126:133], v1
    ds_write_b64 v242, v[54:55] offset:5120
    v_cvt_pk_bf16_f32 v118, |v86|, |v87|
    v_mfma_f32_32x32x16_f16 v[102:117], v[158:161], v[190:193], v[22:37]
    v_cvt_pk_bf16_f32 v120, |v88|, |v89|
    v_cvt_pk_bf16_f32 v122, |v90|, |v91|
    v_cvt_pk_bf16_f32 v124, |v92|, |v93|
    v_cvt_pk_bf16_f32 v126, |v94|, |v95|
    v_cvt_pk_bf16_f32 v128, |v96|, |v97|
    v_cvt_pk_bf16_f32 v130, |v98|, |v99|
    v_mfma_f32_32x32x16_f16 v[102:117], v[162:165], v[194:197], v[102:117]
    v_cvt_pk_bf16_f32 v132, |v100|, |v101|
    v_pk_mul_f16 v183, v3, v183
    v_pk_mul_f16 v184, v4, v184
    v_pk_mul_f16 v185, v5, v185
    v_add_f32_e64 v78, v78, v80
    v_pk_mul_f16 v186, v6, v186
    v_mfma_f32_32x32x16_f16 v[86:101], v[174:177], v[150:153], v[22:37]
    ds_read_b128 v[174:177], v239 offset:48
    v_pk_mul_f16 v187, v7, v187
    v_pk_mul_f16 v188, v8, v188
    v_pk_mul_f16 v189, v9, v189
    v_exp_f32_e64 v56, v78
    v_cvt_pk_bf16_f32 v119, |v102|, |v103|
    v_mfma_f32_32x32x16_f16 v[86:101], v[178:181], v[154:157], v[86:101]
    ds_read_b128 v[178:181], v239 offset:4144
    v_cvt_pk_bf16_f32 v121, |v104|, |v105|
    v_cvt_pk_bf16_f32 v123, |v106|, |v107|
    v_cvt_pk_bf16_f32 v125, |v108|, |v109|
    v_cvt_pk_bf16_f32 v127, |v110|, |v111|
    v_cvt_pk_bf16_f32 v129, |v112|, |v113|
    v_cvt_pk_bf16_f32 v131, |v114|, |v115|
    v_smfmac_f32_16x16x64_bf16 v[64:67], v[38:41], v[118:125], v1
    v_cvt_pk_bf16_f32 v133, |v116|, |v117|
    s_waitcnt lgkmcnt(2)
    v_mfma_f32_16x16x32_f16 v[74:77], v[138:141], v[74:77], 0
    ds_read_b128 v[138:141], v232 offset:24576
    v_add_f32_e32 v79, v79, v81
    v_cvt_pk_bf16_f32 v118, |v86|, |v87|
    v_smfmac_f32_16x16x64_bf16 v[64:67], v[46:49], v[126:133], v1
    v_cvt_pk_bf16_f32 v120, |v88|, |v89|
    v_mfma_f32_32x32x16_f16 v[102:117], v[158:161], v[150:153], v[22:37]
    ds_read_b128 v[158:161], v234 offset:24576
    v_cvt_pk_bf16_f32 v122, |v90|, |v91|
    v_cvt_pk_bf16_f32 v124, |v92|, |v93|
    v_cvt_pk_bf16_f32 v126, |v94|, |v95|
    v_cvt_pk_bf16_f32 v128, |v96|, |v97|
    v_cvt_pk_bf16_f32 v130, |v98|, |v99|
    v_cvt_pk_bf16_f32 v132, |v100|, |v101|
    v_mfma_f32_32x32x16_f16 v[102:117], v[162:165], v[154:157], v[102:117]
    ds_read_b128 v[162:165], v234 offset:28672
    v_mul_f32_e64 v57, v56, v79
    v_pk_mul_f16 v166, v2, v166
    v_pk_mul_f16 v167, v3, v167
    v_pk_mul_f16 v168, v4, v168
    v_pk_mul_f16 v169, v5, v169
    v_pk_mul_f16 v170, v6, v170
    s_waitcnt lgkmcnt(3)
    s_nop 0
    v_mfma_f32_32x32x16_f16 v[86:101], v[182:185], v[190:193], v[22:37]
    ds_read_b128 v[78:81], v240 offset:32800
    v_pk_mul_f16 v171, v7, v171
    v_pk_mul_f16 v172, v8, v172
    v_pk_mul_f16 v173, v9, v173
    v_cvt_pk_bf16_f32 v119, |v102|, |v103|
    v_cvt_pk_bf16_f32 v121, |v104|, |v105|
    v_cvt_pk_bf16_f32 v123, |v106|, |v107|
    v_mfma_f32_32x32x16_f16 v[86:101], v[186:189], v[194:197], v[86:101]
    v_cvt_pk_bf16_f32 v125, |v108|, |v109|
    v_cvt_pk_bf16_f32 v127, |v110|, |v111|
    v_cvt_pk_bf16_f32 v129, |v112|, |v113|
    v_cvt_pk_bf16_f32 v131, |v114|, |v115|
    v_cvt_pk_bf16_f32 v133, |v116|, |v117|
    v_pk_mul_f16 v198, v142, v198
    v_smfmac_f32_16x16x64_bf16 v[72:75], v[38:41], v[118:125], v1
    v_pk_mul_f16 v199, v143, v199
    v_smfmac_f32_16x16x64_bf16 v[72:75], v[46:49], v[126:133], v1
    v_pk_mul_f16 v200, v144, v200
    v_mfma_f32_32x32x16_f16 v[102:117], v[166:169], v[190:193], v[22:37]
    ds_read_b128 v[190:193], v235 offset:24576
    v_cvt_pk_bf16_f32 v118, |v86|, |v87|
    v_cvt_pk_bf16_f32 v120, |v88|, |v89|
    v_cvt_pk_bf16_f32 v122, |v90|, |v91|
    v_cvt_pk_bf16_f32 v124, |v92|, |v93|
    v_cvt_pk_bf16_f32 v126, |v94|, |v95|
    v_cvt_pk_bf16_f32 v128, |v96|, |v97|
    v_mfma_f32_32x32x16_f16 v[102:117], v[170:173], v[194:197], v[102:117]
    ds_read_b128 v[194:197], v235 offset:28672
    v_cvt_pk_bf16_f32 v130, |v98|, |v99|
    v_cvt_pk_bf16_f32 v132, |v100|, |v101|
    v_pk_mul_f16 v201, v145, v201
    v_pk_mul_f16 v202, v146, v202
    v_pk_mul_f16 v203, v147, v203
    v_pk_mul_f16 v204, v148, v204
    v_mfma_f32_32x32x16_f16 v[86:101], v[182:185], v[150:153], v[22:37]
    ds_read_b128 v[182:185], v236 offset:24576
    v_pk_mul_f16 v205, v149, v205
    v_pk_mul_f16 v174, v142, v174
    v_pk_mul_f16 v175, v143, v175
    v_cvt_pk_bf16_f32 v119, |v102|, |v103|
    v_cvt_pk_bf16_f32 v121, |v104|, |v105|
    v_cvt_pk_bf16_f32 v123, |v106|, |v107|
    v_mfma_f32_32x32x16_f16 v[86:101], v[186:189], v[154:157], v[86:101]
    ds_read_b128 v[186:189], v236 offset:28672
    v_cvt_pk_bf16_f32 v125, |v108|, |v109|
    v_cvt_pk_bf16_f32 v127, |v110|, |v111|
    v_cvt_pk_bf16_f32 v129, |v112|, |v113|
    v_cvt_pk_bf16_f32 v131, |v114|, |v115|
    v_cvt_pk_bf16_f32 v133, |v116|, |v117|
    v_pk_mul_f16 v176, v144, v176
    v_smfmac_f32_16x16x64_bf16 v[64:67], v[42:45], v[118:125], v1
    v_pk_mul_f16 v177, v145, v177
    v_smfmac_f32_16x16x64_bf16 v[64:67], v[50:53], v[126:133], v1
    ds_read_b128 v[142:145], v222 offset:24592
    v_add_f32_e32 v82, v82, v84
    s_waitcnt lgkmcnt(4)
    v_smfmac_f32_16x16x64_f16 v[78:81], v[10:13], v[198:205], v218
    v_cvt_pk_bf16_f32 v118, |v86|, |v87|
    v_mfma_f32_32x32x16_f16 v[102:117], v[166:169], v[150:153], v[22:37]
    ds_read_b128 v[166:169], v237 offset:24576
    v_cvt_pk_bf16_f32 v120, |v88|, |v89|
    v_cvt_pk_bf16_f32 v122, |v90|, |v91|
    v_cvt_pk_bf16_f32 v124, |v92|, |v93|
    v_cvt_pk_bf16_f32 v126, |v94|, |v95|
    v_cvt_pk_bf16_f32 v128, |v96|, |v97|
    v_cvt_pk_bf16_f32 v130, |v98|, |v99|
    v_mfma_f32_32x32x16_f16 v[102:117], v[170:173], v[154:157], v[102:117]
    ds_read_b128 v[170:173], v237 offset:28672
    v_cvt_pk_bf16_f32 v132, |v100|, |v101|
    v_pk_mul_f16 v178, v146, v178
    v_pk_mul_f16 v179, v147, v179
    v_pk_mul_f16 v180, v148, v180
    v_pk_mul_f16 v181, v149, v181
    v_exp_f32_e32 v54, v82
    s_waitcnt lgkmcnt(3)
    v_mfma_f32_32x32x16_f16 v[86:101], v[2:5], v[198:201], v[22:37]
    ds_read_b128 v[150:153], v222 offset:24576
    v_add_f32_e64 v83, v83, v85
    v_mul_f32_e64 v55, v54, v83
    v_pk_mul_f16 v190, v158, v190
    v_cvt_pk_bf16_f32 v119, |v102|, |v103|
    v_cvt_pk_bf16_f32 v121, |v104|, |v105|
    v_cvt_pk_bf16_f32 v123, |v106|, |v107|
    v_smfmac_f32_16x16x64_f16 v[78:81], v[14:17], v[174:181], v218
    ds_read_b128 v[198:201], v223 offset:24576
    v_cvt_pk_bf16_f32 v125, |v108|, |v109|
    v_mfma_f32_32x32x16_f16 v[86:101], v[6:9], v[202:205], v[86:101]
    ds_read_b128 v[154:157], v222 offset:28672
    v_cvt_pk_bf16_f32 v127, |v110|, |v111|
    v_cvt_pk_bf16_f32 v129, |v112|, |v113|
    v_cvt_pk_bf16_f32 v131, |v114|, |v115|
    v_cvt_pk_bf16_f32 v133, |v116|, |v117|
    v_pk_mul_f16 v191, v159, v191
    v_pk_mul_f16 v192, v160, v192
    v_smfmac_f32_16x16x64_bf16 v[72:75], v[42:45], v[118:125], v1
    ds_read_b128 v[202:205], v223 offset:28672
    v_pk_mul_f16 v193, v161, v193
    v_smfmac_f32_16x16x64_bf16 v[72:75], v[50:53], v[126:133], v1
    ds_read_b128 v[82:85], v240 offset:32768
    v_cvt_pk_bf16_f32 v118, |v86|, |v87|
    v_mfma_f32_32x32x16_f16 v[102:117], v[2:5], v[174:177], v[22:37]
    ds_read_b128 v[146:149], v222 offset:28688
    v_cvt_pk_bf16_f32 v120, |v88|, |v89|
    v_cvt_pk_bf16_f32 v122, |v90|, |v91|
    v_cvt_pk_bf16_f32 v124, |v92|, |v93|
    v_cvt_pk_bf16_f32 v126, |v94|, |v95|
    v_cvt_pk_bf16_f32 v128, |v96|, |v97|
    v_cvt_pk_bf16_f32 v130, |v98|, |v99|
    v_mfma_f32_32x32x16_f16 v[102:117], v[6:9], v[178:181], v[102:117]
    ds_read_b128 v[174:177], v224 offset:24576
    v_cvt_pk_bf16_f32 v132, |v100|, |v101|
    v_pk_mul_f16 v194, v162, v194
    v_pk_mul_f16 v195, v163, v195
    v_pk_mul_f16 v196, v164, v196
    v_pk_mul_f16 v197, v165, v197
    s_waitcnt lgkmcnt(5)
    s_nop 0
    v_pk_mul_f16 v166, v182, v166
    v_mfma_f32_32x32x16_f16 v[86:101], v[2:5], v[190:193], v[22:37]
    ds_read_b128 v[178:181], v224 offset:28672
    v_pk_mul_f16 v167, v183, v167
    v_pk_mul_f16 v168, v184, v168
    v_pk_mul_f16 v169, v185, v169
    v_cvt_pk_bf16_f32 v119, |v102|, |v103|
    v_cvt_pk_bf16_f32 v121, |v104|, |v105|
    v_cvt_pk_bf16_f32 v123, |v106|, |v107|
    v_mfma_f32_32x32x16_f16 v[86:101], v[6:9], v[194:197], v[86:101]
    ds_read_b128 v[158:161], v222 offset:24608
    v_cvt_pk_bf16_f32 v125, |v108|, |v109|
    v_cvt_pk_bf16_f32 v127, |v110|, |v111|
    v_cvt_pk_bf16_f32 v129, |v112|, |v113|
    v_cvt_pk_bf16_f32 v131, |v114|, |v115|
    v_cvt_pk_bf16_f32 v133, |v116|, |v117|
    v_exp_f32_e64 v60, v60
    v_smfmac_f32_16x16x64_bf16 v[78:81], v[40:43], v[118:125], v1
    ds_read_b128 v[162:165], v222 offset:28704
    v_exp_f32_e64 v62, v62
    v_smfmac_f32_16x16x64_bf16 v[78:81], v[48:51], v[126:133], v1
    ds_read_b128 v[182:185], v222 offset:24624
    v_add_f32_e64 v54, v54, v60
    v_mfma_f32_32x32x16_f16 v[102:117], v[2:5], v[166:169], v[22:37]
    v_fmac_f32_e64 v55, v60, v61
    v_exp_f32_e64 v68, v68
    v_add_f32_e64 v54, v54, v62
    v_fmac_f32_e64 v55, v62, v63
    v_exp_f32_e32 v70, v70
    s_waitcnt lgkmcnt(4)
    v_smfmac_f32_16x16x64_f16 v[82:85], v[10:13], v[190:197], v218
    ds_read_b128 v[58:61], v229 offset:24576
    v_add_f32_e64 v54, v54, v68
    v_fmac_f32_e64 v55, v68, v69
    v_exp_f32_e64 v64, v64
    v_add_f32_e64 v54, v54, v70
    v_fmac_f32_e64 v55, v70, v71
    v_pk_mul_f16 v170, v186, v170
    v_pk_mul_f16 v171, v187, v171
    v_pk_mul_f16 v172, v188, v172
    v_pk_mul_f16 v173, v189, v173
    v_add_f32_e64 v54, v54, v64
    v_fmac_f32_e64 v55, v64, v65
    v_smfmac_f32_16x16x64_f16 v[82:85], v[14:17], v[166:173], v218
    ds_read_b128 v[62:65], v227 offset:25600
    v_cvt_pk_bf16_f32 v118, |v86|, |v87|
    v_mfma_f32_32x32x16_f16 v[102:117], v[6:9], v[170:173], v[102:117]
    ds_read_b128 v[186:189], v222 offset:28720
    v_cvt_pk_bf16_f32 v120, |v88|, |v89|
    v_cvt_pk_bf16_f32 v122, |v90|, |v91|
    v_cvt_pk_bf16_f32 v124, |v92|, |v93|
    v_cvt_pk_bf16_f32 v126, |v94|, |v95|
    v_cvt_pk_bf16_f32 v128, |v96|, |v97|
    v_cvt_pk_bf16_f32 v130, |v98|, |v99|
    v_cvt_pk_bf16_f32 v132, |v100|, |v101|
    v_pk_mul_f16 v150, v2, v150
    v_pk_mul_f16 v151, v3, v151
    v_pk_mul_f16 v152, v4, v152
    v_pk_mul_f16 v153, v5, v153
    v_pk_mul_f16 v154, v6, v154
    v_pk_mul_f16 v155, v7, v155
    s_waitcnt lgkmcnt(3)
    s_nop 0
    v_mfma_f32_32x32x16_f16 v[86:101], v[150:153], v[198:201], v[22:37]
    ds_read_b128 v[190:193], v222 offset:24640
    v_pk_mul_f16 v156, v8, v156
    v_pk_mul_f16 v157, v9, v157
    v_cvt_pk_bf16_f32 v119, |v102|, |v103|
    v_cvt_pk_bf16_f32 v121, |v104|, |v105|
    v_cvt_pk_bf16_f32 v123, |v106|, |v107|
    v_cvt_pk_bf16_f32 v125, |v108|, |v109|
    v_mfma_f32_32x32x16_f16 v[86:101], v[154:157], v[202:205], v[86:101]
    ds_read_b128 v[194:197], v222 offset:28736
    v_cvt_pk_bf16_f32 v127, |v110|, |v111|
    v_cvt_pk_bf16_f32 v129, |v112|, |v113|
    v_cvt_pk_bf16_f32 v131, |v114|, |v115|
    v_cvt_pk_bf16_f32 v133, |v116|, |v117|
    v_pk_mul_f16 v142, v2, v142
    v_pk_mul_f16 v143, v3, v143
    v_smfmac_f32_16x16x64_bf16 v[82:85], v[40:43], v[118:125], v1
    ds_read_b128 v[166:169], v222 offset:24656
    v_pk_mul_f16 v144, v4, v144
    v_smfmac_f32_16x16x64_bf16 v[82:85], v[48:51], v[126:133], v1
    ds_read_b128 v[170:173], v222 offset:28752
    v_pk_mul_f16 v145, v5, v145
    v_exp_f32_e64 v66, v66
    v_exp_f32_e64 v72, v72
    v_mfma_f32_32x32x16_f16 v[102:117], v[142:145], v[198:201], v[22:37]
    v_add_f32_e64 v54, v54, v66
    v_fmac_f32_e64 v55, v66, v67
    v_pk_mul_f16 v146, v6, v146
    v_pk_mul_f16 v147, v7, v147
    v_pk_mul_f16 v148, v8, v148
    v_pk_mul_f16 v149, v9, v149
    v_add_f32_e64 v54, v54, v72
    v_fmac_f32_e64 v55, v72, v73
    v_mfma_f32_32x32x16_f16 v[102:117], v[146:149], v[202:205], v[102:117]
    ds_read_b128 v[66:69], v227 offset:25856
    v_cvt_pk_bf16_f32 v118, |v86|, |v87|
    v_cvt_pk_bf16_f32 v120, |v88|, |v89|
    v_cvt_pk_bf16_f32 v122, |v90|, |v91|
    v_cvt_pk_bf16_f32 v124, |v92|, |v93|
    v_cvt_pk_bf16_f32 v126, |v94|, |v95|
    v_cvt_pk_bf16_f32 v128, |v96|, |v97|
    v_cvt_pk_bf16_f32 v130, |v98|, |v99|
    v_cvt_pk_bf16_f32 v132, |v100|, |v101|
    s_waitcnt lgkmcnt(3)
    s_setprio 0
    v_mfma_f32_32x32x16_f16 v[86:101], v[150:153], v[174:177], v[22:37]
    ds_read_b128 v[70:73], v228 offset:24576
    v_pk_mul_f16 v134, v134, v18
    v_cvt_pk_bf16_f32 v119, |v102|, |v103|
    v_cvt_pk_bf16_f32 v121, |v104|, |v105|
    v_cvt_pk_bf16_f32 v123, |v106|, |v107|
    v_cvt_pk_bf16_f32 v125, |v108|, |v109|
    v_cvt_pk_bf16_f32 v127, |v110|, |v111|
    v_mfma_f32_32x32x16_f16 v[86:101], v[154:157], v[178:181], v[86:101]
    ds_read_b128 v[150:153], v225 offset:24576
    v_cvt_pk_bf16_f32 v129, |v112|, |v113|
    v_cvt_pk_bf16_f32 v131, |v114|, |v115|
    v_cvt_pk_bf16_f32 v133, |v116|, |v117|
    v_pk_mul_f16 v135, v135, v19
    v_pk_mul_f16 v136, v136, v20
    v_pk_mul_f16 v137, v137, v21
    v_mfma_f32_32x32x16_f16 v[102:117], v[142:145], v[174:177], v[22:37]
    ds_read_b128 v[154:157], v225 offset:28672
    v_pk_mul_f16 v138, v138, v18
    v_pk_mul_f16 v139, v139, v19
    v_pk_mul_f16 v140, v140, v20
    v_pk_mul_f16 v141, v141, v21
    v_pk_mul_f16 v158, v2, v158
    v_pk_mul_f16 v159, v3, v159
    v_mfma_f32_16x16x32_f16 v[58:61], v[138:141], v[58:61], 0
    ds_read_b128 v[142:145], v226 offset:24576
    v_pk_mul_f16 v160, v4, v160
    v_pk_mul_f16 v161, v5, v161
    v_mfma_f32_16x16x32_f16 v[62:65], v[134:137], v[62:65], 0
    v_pk_mul_f16 v162, v6, v162
    v_pk_mul_f16 v163, v7, v163
    v_mfma_f32_32x32x16_f16 v[102:117], v[146:149], v[178:181], v[102:117]
    ds_read_b128 v[146:149], v226 offset:28672
    v_pk_mul_f16 v164, v8, v164
    v_pk_mul_f16 v165, v9, v165
    v_pk_mul_f16 v182, v2, v182
    v_pk_mul_f16 v183, v3, v183
    v_pk_mul_f16 v184, v4, v184
    v_pk_mul_f16 v185, v5, v185
    v_smfmac_f32_16x16x64_bf16 v[60:63], v[38:41], v[118:125], v1
    v_cvt_pk_bf16_f32 v118, |v86|, |v87|
    v_smfmac_f32_16x16x64_bf16 v[60:63], v[46:49], v[126:133], v1
    v_cvt_pk_bf16_f32 v120, |v88|, |v89|
    s_waitcnt lgkmcnt(3)
    s_nop 0
    v_mfma_f32_16x16x32_f16 v[66:69], v[138:141], v[66:69], 0
    v_cvt_pk_bf16_f32 v122, |v90|, |v91|
    v_cvt_pk_bf16_f32 v124, |v92|, |v93|
    v_mfma_f32_16x16x32_f16 v[70:73], v[134:137], v[70:73], 0
    v_cvt_pk_bf16_f32 v126, |v94|, |v95|
    v_cvt_pk_bf16_f32 v128, |v96|, |v97|
    v_cvt_pk_bf16_f32 v130, |v98|, |v99|
    v_cvt_pk_bf16_f32 v132, |v100|, |v101|
    s_waitcnt lgkmcnt(2)
    s_nop 0
    v_mfma_f32_32x32x16_f16 v[86:101], v[158:161], v[198:201], v[22:37]
    v_cvt_pk_bf16_f32 v119, |v102|, |v103|
    v_cvt_pk_bf16_f32 v121, |v104|, |v105|
    v_cvt_pk_bf16_f32 v123, |v106|, |v107|
    v_cvt_pk_bf16_f32 v125, |v108|, |v109|
    v_cvt_pk_bf16_f32 v127, |v110|, |v111|
    v_cvt_pk_bf16_f32 v129, |v112|, |v113|
    v_smfmac_f32_16x16x64_bf16 v[68:71], v[38:41], v[118:125], v1
    v_cvt_pk_bf16_f32 v131, |v114|, |v115|
    v_mfma_f32_32x32x16_f16 v[86:101], v[162:165], v[202:205], v[86:101]
    v_cvt_pk_bf16_f32 v133, |v116|, |v117|
    v_pk_mul_f16 v186, v6, v186
    v_pk_mul_f16 v187, v7, v187
    v_pk_mul_f16 v188, v8, v188
    v_pk_mul_f16 v189, v9, v189
    v_pk_mul_f16 v190, v2, v190
    v_smfmac_f32_16x16x64_bf16 v[68:71], v[46:49], v[126:133], v1
    v_pk_mul_f16 v191, v3, v191
    v_mfma_f32_32x32x16_f16 v[102:117], v[182:185], v[198:201], v[22:37]
    ds_read_b128 v[198:201], v222 offset:24672
    v_pk_mul_f16 v192, v4, v192
    v_pk_mul_f16 v193, v5, v193
    v_cvt_pk_bf16_f32 v118, |v86|, |v87|
    v_cvt_pk_bf16_f32 v120, |v88|, |v89|
    v_cvt_pk_bf16_f32 v122, |v90|, |v91|
    v_cvt_pk_bf16_f32 v124, |v92|, |v93|
    v_mfma_f32_32x32x16_f16 v[102:117], v[186:189], v[202:205], v[102:117]
    ds_read_b128 v[202:205], v222 offset:28768
    v_cvt_pk_bf16_f32 v126, |v94|, |v95|
    v_cvt_pk_bf16_f32 v128, |v96|, |v97|
    v_cvt_pk_bf16_f32 v130, |v98|, |v99|
    v_cvt_pk_bf16_f32 v132, |v100|, |v101|
    v_pk_mul_f16 v194, v6, v194
    v_pk_mul_f16 v195, v7, v195
    v_mfma_f32_32x32x16_f16 v[86:101], v[158:161], v[174:177], v[22:37]
    ds_read_b128 v[158:161], v222 offset:24688
    v_pk_mul_f16 v196, v8, v196
    v_pk_mul_f16 v197, v9, v197
    v_pk_mul_f16 v166, v2, v166
    v_cvt_pk_bf16_f32 v119, |v102|, |v103|
    v_cvt_pk_bf16_f32 v121, |v104|, |v105|
    v_cvt_pk_bf16_f32 v123, |v106|, |v107|
    v_mfma_f32_32x32x16_f16 v[86:101], v[162:165], v[178:181], v[86:101]
    ds_read_b128 v[162:165], v222 offset:28784
    v_cvt_pk_bf16_f32 v125, |v108|, |v109|
    v_cvt_pk_bf16_f32 v127, |v110|, |v111|
    v_cvt_pk_bf16_f32 v129, |v112|, |v113|
    v_cvt_pk_bf16_f32 v131, |v114|, |v115|
    v_cvt_pk_bf16_f32 v133, |v116|, |v117|
    v_pk_mul_f16 v167, v3, v167
    v_smfmac_f32_16x16x64_bf16 v[60:63], v[42:45], v[118:125], v1
    v_pk_mul_f16 v168, v4, v168
    v_smfmac_f32_16x16x64_bf16 v[60:63], v[50:53], v[126:133], v1
    v_pk_mul_f16 v169, v5, v169
    v_mfma_f32_32x32x16_f16 v[102:117], v[182:185], v[174:177], v[22:37]
    ds_read_b128 v[182:185], v238 offset:0
    v_cvt_pk_bf16_f32 v118, |v86|, |v87|
    v_cvt_pk_bf16_f32 v120, |v88|, |v89|
    v_cvt_pk_bf16_f32 v122, |v90|, |v91|
    v_cvt_pk_bf16_f32 v124, |v92|, |v93|
    v_cvt_pk_bf16_f32 v126, |v94|, |v95|
    v_cvt_pk_bf16_f32 v128, |v96|, |v97|
    v_mfma_f32_32x32x16_f16 v[102:117], v[186:189], v[178:181], v[102:117]
    ds_read_b128 v[174:177], v239 offset:64
    v_cvt_pk_bf16_f32 v130, |v98|, |v99|
    v_cvt_pk_bf16_f32 v132, |v100|, |v101|
    v_exp_f32_e64 v74, v74
    v_pk_mul_f16 v170, v6, v170
    v_pk_mul_f16 v171, v7, v171
    s_waitcnt lgkmcnt(3)
    s_nop 0
    v_mfma_f32_32x32x16_f16 v[86:101], v[190:193], v[150:153], v[22:37]
    ds_read_b128 v[186:189], v238 offset:4096
    v_pk_mul_f16 v172, v8, v172
    v_pk_mul_f16 v173, v9, v173
    v_add_f32_e64 v54, v54, v74
    v_fmac_f32_e64 v55, v74, v75
    v_cvt_pk_bf16_f32 v119, |v102|, |v103|
    v_cvt_pk_bf16_f32 v121, |v104|, |v105|
    v_mfma_f32_32x32x16_f16 v[86:101], v[194:197], v[154:157], v[86:101]
    ds_read_b128 v[74:77], v230 offset:24576
    v_cvt_pk_bf16_f32 v123, |v106|, |v107|
    v_cvt_pk_bf16_f32 v125, |v108|, |v109|
    v_cvt_pk_bf16_f32 v127, |v110|, |v111|
    v_cvt_pk_bf16_f32 v129, |v112|, |v113|
    v_cvt_pk_bf16_f32 v131, |v114|, |v115|
    v_cvt_pk_bf16_f32 v133, |v116|, |v117|
    v_smfmac_f32_16x16x64_bf16 v[68:71], v[42:45], v[118:125], v1
    ds_read_b128 v[178:181], v239 offset:4160
    v_pk_mul_f16 v198, v2, v198
    v_smfmac_f32_16x16x64_bf16 v[68:71], v[50:53], v[126:133], v1
    ds_write_b64 v242, v[54:55] offset:10240
    v_cvt_pk_bf16_f32 v118, |v86|, |v87|
    v_mfma_f32_32x32x16_f16 v[102:117], v[166:169], v[150:153], v[22:37]
    v_cvt_pk_bf16_f32 v120, |v88|, |v89|
    v_cvt_pk_bf16_f32 v122, |v90|, |v91|
    v_cvt_pk_bf16_f32 v124, |v92|, |v93|
    v_cvt_pk_bf16_f32 v126, |v94|, |v95|
    v_cvt_pk_bf16_f32 v128, |v96|, |v97|
    v_cvt_pk_bf16_f32 v130, |v98|, |v99|
    v_mfma_f32_32x32x16_f16 v[102:117], v[170:173], v[154:157], v[102:117]
    v_cvt_pk_bf16_f32 v132, |v100|, |v101|
    v_pk_mul_f16 v199, v3, v199
    v_pk_mul_f16 v200, v4, v200
    v_pk_mul_f16 v201, v5, v201
    v_pk_mul_f16 v202, v6, v202
    v_pk_mul_f16 v203, v7, v203
    v_mfma_f32_32x32x16_f16 v[86:101], v[190:193], v[142:145], v[22:37]
    ds_read_b128 v[190:193], v239 offset:80
    v_pk_mul_f16 v204, v8, v204
    v_pk_mul_f16 v205, v9, v205
    v_pk_mul_f16 v158, v2, v158
    v_pk_mul_f16 v159, v3, v159
    v_cvt_pk_bf16_f32 v119, |v102|, |v103|
    v_cvt_pk_bf16_f32 v121, |v104|, |v105|
    v_mfma_f32_32x32x16_f16 v[86:101], v[194:197], v[146:149], v[86:101]
    ds_read_b128 v[194:197], v239 offset:4176
    v_cvt_pk_bf16_f32 v123, |v106|, |v107|
    v_cvt_pk_bf16_f32 v125, |v108|, |v109|
    v_cvt_pk_bf16_f32 v127, |v110|, |v111|
    v_cvt_pk_bf16_f32 v129, |v112|, |v113|
    v_cvt_pk_bf16_f32 v131, |v114|, |v115|
    v_cvt_pk_bf16_f32 v133, |v116|, |v117|
    v_smfmac_f32_16x16x64_bf16 v[64:67], v[38:41], v[118:125], v1
    v_pk_mul_f16 v160, v4, v160
    v_smfmac_f32_16x16x64_bf16 v[64:67], v[46:49], v[126:133], v1
    v_pk_mul_f16 v161, v5, v161
    s_waitcnt lgkmcnt(2)
    s_nop 0
    v_mfma_f32_16x16x32_f16 v[74:77], v[138:141], v[74:77], 0
    v_cvt_pk_bf16_f32 v118, |v86|, |v87|
    v_cvt_pk_bf16_f32 v120, |v88|, |v89|
    v_mfma_f32_32x32x16_f16 v[102:117], v[166:169], v[142:145], v[22:37]
    v_cvt_pk_bf16_f32 v122, |v90|, |v91|
    v_cvt_pk_bf16_f32 v124, |v92|, |v93|
    v_cvt_pk_bf16_f32 v126, |v94|, |v95|
    v_cvt_pk_bf16_f32 v128, |v96|, |v97|
    v_cvt_pk_bf16_f32 v130, |v98|, |v99|
    v_cvt_pk_bf16_f32 v132, |v100|, |v101|
    v_mfma_f32_32x32x16_f16 v[102:117], v[170:173], v[146:149], v[102:117]
    v_pk_mul_f16 v162, v6, v162
    v_pk_mul_f16 v163, v7, v163
    v_pk_mul_f16 v164, v8, v164
    v_pk_mul_f16 v165, v9, v165
    v_add_f32_e64 v78, v78, v80
    v_exp_f32_e32 v78, v78
    s_waitcnt lgkmcnt(1)
    v_mfma_f32_32x32x16_f16 v[86:101], v[198:201], v[150:153], v[22:37]
    v_add_f32_e64 v79, v79, v81
    v_add_f32_e64 v56, v56, v78
    v_fmac_f32_e64 v57, v78, v79
    v_pk_mul_f16 v174, v182, v174
    v_pk_mul_f16 v175, v183, v175
    v_cvt_pk_bf16_f32 v119, |v102|, |v103|
    v_mfma_f32_32x32x16_f16 v[86:101], v[202:205], v[154:157], v[86:101]
    ds_read_b128 v[78:81], v240 offset:32800
    v_cvt_pk_bf16_f32 v121, |v104|, |v105|
    v_cvt_pk_bf16_f32 v123, |v106|, |v107|
    v_cvt_pk_bf16_f32 v125, |v108|, |v109|
    v_cvt_pk_bf16_f32 v127, |v110|, |v111|
    v_cvt_pk_bf16_f32 v129, |v112|, |v113|
    v_cvt_pk_bf16_f32 v131, |v114|, |v115|
    v_smfmac_f32_16x16x64_bf16 v[72:75], v[38:41], v[118:125], v1
    v_cvt_pk_bf16_f32 v133, |v116|, |v117|
    v_mfma_f32_32x32x16_f16 v[102:117], v[158:161], v[150:153], v[22:37]
    v_pk_mul_f16 v176, v184, v176
    v_pk_mul_f16 v177, v185, v177
    v_cvt_pk_bf16_f32 v118, |v86|, |v87|
    v_cvt_pk_bf16_f32 v120, |v88|, |v89|
    v_cvt_pk_bf16_f32 v122, |v90|, |v91|
    v_cvt_pk_bf16_f32 v124, |v92|, |v93|
    v_smfmac_f32_16x16x64_bf16 v[72:75], v[46:49], v[126:133], v1
    v_cvt_pk_bf16_f32 v126, |v94|, |v95|
    v_mfma_f32_32x32x16_f16 v[102:117], v[162:165], v[154:157], v[102:117]
    v_cvt_pk_bf16_f32 v128, |v96|, |v97|
    v_cvt_pk_bf16_f32 v130, |v98|, |v99|
    v_cvt_pk_bf16_f32 v132, |v100|, |v101|
    v_pk_mul_f16 v178, v186, v178
    v_pk_mul_f16 v179, v187, v179
    v_pk_mul_f16 v180, v188, v180
    v_mfma_f32_32x32x16_f16 v[86:101], v[198:201], v[142:145], v[22:37]
    v_pk_mul_f16 v181, v189, v181
    v_pk_mul_f16 v190, v182, v190
    v_pk_mul_f16 v191, v183, v191
    v_pk_mul_f16 v192, v184, v192
    v_pk_mul_f16 v193, v185, v193
    v_cvt_pk_bf16_f32 v119, |v102|, |v103|
    v_mfma_f32_32x32x16_f16 v[86:101], v[202:205], v[146:149], v[86:101]
    v_cvt_pk_bf16_f32 v121, |v104|, |v105|
    v_cvt_pk_bf16_f32 v123, |v106|, |v107|
    v_cvt_pk_bf16_f32 v125, |v108|, |v109|
    v_cvt_pk_bf16_f32 v127, |v110|, |v111|
    v_cvt_pk_bf16_f32 v129, |v112|, |v113|
    v_cvt_pk_bf16_f32 v131, |v114|, |v115|
    v_smfmac_f32_16x16x64_bf16 v[64:67], v[42:45], v[118:125], v1
    v_cvt_pk_bf16_f32 v133, |v116|, |v117|
    s_waitcnt lgkmcnt(0)
    s_nop 0
    v_smfmac_f32_16x16x64_f16 v[78:81], v[10:13], v[174:181], v218
    v_pk_mul_f16 v194, v186, v194
    v_smfmac_f32_16x16x64_bf16 v[64:67], v[50:53], v[126:133], v1
    v_pk_mul_f16 v195, v187, v195
    v_mfma_f32_32x32x16_f16 v[102:117], v[158:161], v[142:145], v[22:37]
    v_cvt_pk_bf16_f32 v118, |v86|, |v87|
    v_cvt_pk_bf16_f32 v120, |v88|, |v89|
    v_cvt_pk_bf16_f32 v122, |v90|, |v91|
    v_cvt_pk_bf16_f32 v124, |v92|, |v93|
    v_cvt_pk_bf16_f32 v126, |v94|, |v95|
    v_cvt_pk_bf16_f32 v128, |v96|, |v97|
    v_mfma_f32_32x32x16_f16 v[102:117], v[162:165], v[146:149], v[102:117]
    v_cvt_pk_bf16_f32 v130, |v98|, |v99|
    v_cvt_pk_bf16_f32 v132, |v100|, |v101|
    v_pk_mul_f16 v196, v188, v196
    v_pk_mul_f16 v197, v189, v197
    v_add_f32_e64 v82, v82, v84
    v_exp_f32_e64 v54, v82
    v_smfmac_f32_16x16x64_f16 v[78:81], v[14:17], v[190:197], v218
    v_add_f32_e64 v83, v83, v85
    v_mfma_f32_32x32x16_f16 v[86:101], v[2:5], v[174:177], v[22:37]
    v_exp_f32_e64 v60, v60
    v_mul_f32_e64 v55, v54, v83
    v_exp_f32_e64 v62, v62
    v_cvt_pk_bf16_f32 v119, |v102|, |v103|
    v_mfma_f32_32x32x16_f16 v[86:101], v[6:9], v[178:181], v[86:101]
    v_cvt_pk_bf16_f32 v121, |v104|, |v105|
    v_cvt_pk_bf16_f32 v123, |v106|, |v107|
    v_cvt_pk_bf16_f32 v125, |v108|, |v109|
    v_cvt_pk_bf16_f32 v127, |v110|, |v111|
    v_cvt_pk_bf16_f32 v129, |v112|, |v113|
    v_cvt_pk_bf16_f32 v131, |v114|, |v115|
    v_smfmac_f32_16x16x64_bf16 v[72:75], v[42:45], v[118:125], v1
    v_cvt_pk_bf16_f32 v133, |v116|, |v117|
    v_mfma_f32_32x32x16_f16 v[102:117], v[2:5], v[190:193], v[22:37]
    v_add_f32_e64 v54, v54, v60
    v_fmac_f32_e64 v55, v60, v61
    v_exp_f32_e64 v68, v68
    v_cvt_pk_bf16_f32 v118, |v86|, |v87|
    v_cvt_pk_bf16_f32 v120, |v88|, |v89|
    v_smfmac_f32_16x16x64_bf16 v[72:75], v[50:53], v[126:133], v1
    v_cvt_pk_bf16_f32 v122, |v90|, |v91|
    v_mfma_f32_32x32x16_f16 v[102:117], v[6:9], v[194:197], v[102:117]
    v_cvt_pk_bf16_f32 v124, |v92|, |v93|
    v_cvt_pk_bf16_f32 v126, |v94|, |v95|
    v_cvt_pk_bf16_f32 v128, |v96|, |v97|
    v_cvt_pk_bf16_f32 v130, |v98|, |v99|
    v_cvt_pk_bf16_f32 v132, |v100|, |v101|
    v_add_f32_e64 v54, v54, v62
    v_fmac_f32_e64 v55, v62, v63
    v_exp_f32_e64 v70, v70
    v_add_f32_e64 v54, v54, v68
    v_fmac_f32_e64 v55, v68, v69
    v_exp_f32_e64 v64, v64
    v_add_f32_e64 v54, v54, v70
    v_cvt_pk_bf16_f32 v119, |v102|, |v103|
    v_cvt_pk_bf16_f32 v121, |v104|, |v105|
    v_cvt_pk_bf16_f32 v123, |v106|, |v107|
    v_cvt_pk_bf16_f32 v125, |v108|, |v109|
    v_cvt_pk_bf16_f32 v127, |v110|, |v111|
    v_cvt_pk_bf16_f32 v129, |v112|, |v113|
    v_smfmac_f32_16x16x64_bf16 v[78:81], v[40:43], v[118:125], v1
    v_cvt_pk_bf16_f32 v131, |v114|, |v115|
    v_cvt_pk_bf16_f32 v133, |v116|, |v117|
    v_fmac_f32_e64 v55, v70, v71
    v_exp_f32_e64 v66, v66
    v_smfmac_f32_16x16x64_bf16 v[78:81], v[48:51], v[126:133], v1
    v_add_f32_e64 v54, v54, v64
    v_fmac_f32_e64 v55, v64, v65
    v_exp_f32_e64 v72, v72
    v_add_f32_e64 v54, v54, v66
    v_fmac_f32_e64 v55, v66, v67
    v_exp_f32_e64 v74, v74
    v_add_f32_e64 v54, v54, v72
    v_fmac_f32_e64 v55, v72, v73
    v_add_f32_e64 v78, v78, v80
    v_exp_f32_e64 v78, v78
    v_add_f32_e64 v79, v79, v81
    v_add_f32_e64 v54, v54, v74
    v_fmac_f32_e64 v55, v74, v75
    v_add_f32_e64 v56, v56, v78
    v_fmac_f32_e64 v57, v78, v79
    v_add_u32 v220, s57, v244
    ds_write_b64 v242, v[54:55] offset:15360
    ds_write_b64 v243, v[56:57]
    v_subrev_u32 v220, 20480, v220
    s_mul_hi_u32 s37, s2, 0x28f5c29
    s_add_u32 s37, s37, s36
    s_lshl_b32 s3, s37, 1
    s_mov_b32 s48, 0x0d800000
    s_mov_b32 s49, 0x71800000
    s_mov_b32 s50, 0x3d800000
    s_waitcnt lgkmcnt(0)
    s_barrier
    s_cmp_ge_u32 s36, 4
    s_cbranch_scc1 L_fin
    ds_read_b128 v[142:145], v220 offset:0
    ds_read_b128 v[146:149], v220 offset:1024
    ds_read_b128 v[150:153], v220 offset:2048
    ds_read_b128 v[154:157], v220 offset:3072
    ds_read_b128 v[158:161], v220 offset:4096
    ds_read_b32 v169, v244 offset:9216
    s_mov_b32 s52, 0
    s_brev_b32 s53, 1
    s_waitcnt lgkmcnt(4)
    v_pk_add_f32 v[142:143], v[142:143], v[144:145]
    v_pk_add_f32 v[146:147], v[146:147], v[148:149]
    s_waitcnt lgkmcnt(2)
    v_pk_add_f32 v[150:151], v[150:151], v[152:153]
    v_pk_add_f32 v[154:155], v[154:155], v[156:157]
    v_pk_add_f32 v[142:143], v[142:143], v[146:147]
    s_waitcnt lgkmcnt(0)
    v_pk_add_f32 v[158:159], v[158:159], v[160:161]
    v_pk_add_f32 v[150:151], v[150:151], v[154:155]
    v_pk_add_f32 v[142:143], v[142:143], v[158:159]
    v_pk_add_f32 v[142:143], v[142:143], v[150:151]
    v_cmp_le_f32 s[46:47], s54, v169
    s_nop 0
    v_add_f32_dpp v142, v142, v142 row_shr:1 row_mask:0xf bank_mask:0xf bound_ctrl:0
    v_add_f32_dpp v143, v143, v143 row_shr:1 row_mask:0xf bank_mask:0xf bound_ctrl:0
    s_nop 0
    v_add_f32_dpp v142, v142, v142 row_shr:2 row_mask:0xf bank_mask:0xf bound_ctrl:0
    v_add_f32_dpp v143, v143, v143 row_shr:2 row_mask:0xf bank_mask:0xf bound_ctrl:0
    s_nop 0
    v_add_f32_dpp v142, v142, v142 row_shr:4 row_mask:0xf bank_mask:0xf bound_ctrl:0
    v_add_f32_dpp v143, v143, v143 row_shr:4 row_mask:0xf bank_mask:0xf bound_ctrl:0
    s_nop 0
    v_add_f32_dpp v142, v142, v142 row_shr:8 row_mask:0xf bank_mask:0xf bound_ctrl:0
    v_add_f32_dpp v143, v143, v143 row_shr:8 row_mask:0xf bank_mask:0xf bound_ctrl:0
    s_nop 0
    v_add_f32_dpp v142, v142, v142 row_bcast:15 row_mask:0xa bank_mask:0xf
    v_add_f32_dpp v143, v143, v143 row_bcast:15 row_mask:0xa bank_mask:0xf
    s_nop 0
    v_add_f32_dpp v142, v142, v142 row_bcast:31 row_mask:0xc bank_mask:0xf
    v_add_f32_dpp v143, v143, v143 row_bcast:31 row_mask:0xc bank_mask:0xf
    v_rcp_f32 v144, v142
    v_mul_f32 v145, s50, v143
    v_mul_f32 v145, v145, v144
    s_mov_b64 exec, s[52:53]
    v_cvt_pk_bf16_f32 v145, v145, v145
    buffer_store_short v145, off, s[28:31], s3
    v_cmp_le_f32 s[42:43], s48, v142
    v_cmp_ge_f32 s[44:45], s49, v142
    v_cmp_lt_f32 vcc, |v143|, s41
    s_cmp_eq_u64 s[46:47], 0
    s_cselect_b32 s47, s43, 0
    s_and_b32 s47, s47, s45
    s_and_b32 s47, s47, vcc_hi
    s_cbranch_scc0 L_fallback
L_fin:
L_end:
    s_endpgm
L_fallback:
    s_mov_b64 exec, -1
    s_waitcnt vmcnt(0)
    s_load_dwordx4 s[44:47], s[0:1], 16
    s_load_dwordx8 s[64:71], s[0:1], 32
    s_waitcnt lgkmcnt(0)
    s_mov_b32 s6, 409600
    s_mov_b32 s7, 0x00020000
    s_mov_b32 s12, s64
    s_mov_b32 s13, s65
    s_mov_b32 s14, 2048
    s_mov_b32 s15, 0x00020000
    s_mov_b32 s16, s66
    s_mov_b32 s17, s67
    s_mov_b32 s18, 64
    s_mov_b32 s19, 0x00020000
    s_mov_b32 s20, s68
    s_mov_b32 s21, s69
    s_mov_b32 s22, 64
    s_mov_b32 s23, 0x00020000
    s_mov_b32 s24, s70
    s_mov_b32 s25, s71
    s_mov_b32 s26, 64
    s_mov_b32 s27, 0x00020000
    s_mov_b32 s48, s44
    s_mov_b32 s49, s45
    s_mov_b32 s50, 19800
    s_mov_b32 s51, 0x00020000
    s_mov_b32 s52, s46
    s_mov_b32 s53, s47
    s_mov_b32 s54, 19800
    s_mov_b32 s55, 0x00020000
    s_lshl_b32 s38, s36, 13
    s_mul_i32 s3, s37, 400
    v_and_b32 v1, 63, v0
    v_lshrrev_b32 v7, 2, v1
    v_and_b32 v2, 3, v1
    v_lshlrev_b32 v2, 4, v2
    v_add_u32 v3, 0, v7
    v_min_u32 v3, 99, v3
    v_lshlrev_b32 v4, 2, v3
    buffer_load_dword v5, v4, s[4:7], s3 offen
    s_waitcnt vmcnt(0)
    v_lshl_add_u32 v5, v5, 6, v2
    buffer_load_dwordx4 v[8:11], v5, s[8:11], 0 offen
    v_lshl_add_u32 v6, v3, 6, v2
    v_add_u32 v6, s38, v6
    s_waitcnt vmcnt(0)
    ds_write_b128 v6, v[8:11]
    v_add_u32 v3, 16, v7
    v_min_u32 v3, 99, v3
    v_lshlrev_b32 v4, 2, v3
    buffer_load_dword v5, v4, s[4:7], s3 offen
    s_waitcnt vmcnt(0)
    v_lshl_add_u32 v5, v5, 6, v2
    buffer_load_dwordx4 v[8:11], v5, s[8:11], 0 offen
    v_lshl_add_u32 v6, v3, 6, v2
    v_add_u32 v6, s38, v6
    s_waitcnt vmcnt(0)
    ds_write_b128 v6, v[8:11]
    v_add_u32 v3, 32, v7
    v_min_u32 v3, 99, v3
    v_lshlrev_b32 v4, 2, v3
    buffer_load_dword v5, v4, s[4:7], s3 offen
    s_waitcnt vmcnt(0)
    v_lshl_add_u32 v5, v5, 6, v2
    buffer_load_dwordx4 v[8:11], v5, s[8:11], 0 offen
    v_lshl_add_u32 v6, v3, 6, v2
    v_add_u32 v6, s38, v6
    s_waitcnt vmcnt(0)
    ds_write_b128 v6, v[8:11]
    v_add_u32 v3, 48, v7
    v_min_u32 v3, 99, v3
    v_lshlrev_b32 v4, 2, v3
    buffer_load_dword v5, v4, s[4:7], s3 offen
    s_waitcnt vmcnt(0)
    v_lshl_add_u32 v5, v5, 6, v2
    buffer_load_dwordx4 v[8:11], v5, s[8:11], 0 offen
    v_lshl_add_u32 v6, v3, 6, v2
    v_add_u32 v6, s38, v6
    s_waitcnt vmcnt(0)
    ds_write_b128 v6, v[8:11]
    v_add_u32 v3, 64, v7
    v_min_u32 v3, 99, v3
    v_lshlrev_b32 v4, 2, v3
    buffer_load_dword v5, v4, s[4:7], s3 offen
    s_waitcnt vmcnt(0)
    v_lshl_add_u32 v5, v5, 6, v2
    buffer_load_dwordx4 v[8:11], v5, s[8:11], 0 offen
    v_lshl_add_u32 v6, v3, 6, v2
    v_add_u32 v6, s38, v6
    s_waitcnt vmcnt(0)
    ds_write_b128 v6, v[8:11]
    v_add_u32 v3, 80, v7
    v_min_u32 v3, 99, v3
    v_lshlrev_b32 v4, 2, v3
    buffer_load_dword v5, v4, s[4:7], s3 offen
    s_waitcnt vmcnt(0)
    v_lshl_add_u32 v5, v5, 6, v2
    buffer_load_dwordx4 v[8:11], v5, s[8:11], 0 offen
    v_lshl_add_u32 v6, v3, 6, v2
    v_add_u32 v6, s38, v6
    s_waitcnt vmcnt(0)
    ds_write_b128 v6, v[8:11]
    v_add_u32 v3, 96, v7
    v_min_u32 v3, 99, v3
    v_lshlrev_b32 v4, 2, v3
    buffer_load_dword v5, v4, s[4:7], s3 offen
    s_waitcnt vmcnt(0)
    v_lshl_add_u32 v5, v5, 6, v2
    buffer_load_dwordx4 v[8:11], v5, s[8:11], 0 offen
    v_lshl_add_u32 v6, v3, 6, v2
    v_add_u32 v6, s38, v6
    s_waitcnt vmcnt(0)
    ds_write_b128 v6, v[8:11]
    v_and_b32 v2, 31, v0
    v_lshrrev_b32 v3, 5, v1
    v_lshlrev_b32 v4, 10, v3
    v_lshl_add_u32 v4, v2, 1, v4
    buffer_load_ushort v64, v4, s[12:15], 0 offen offset:0
    buffer_load_ushort v65, v4, s[12:15], 0 offen offset:64
    buffer_load_ushort v66, v4, s[12:15], 0 offen offset:128
    buffer_load_ushort v67, v4, s[12:15], 0 offen offset:192
    buffer_load_ushort v68, v4, s[12:15], 0 offen offset:256
    buffer_load_ushort v69, v4, s[12:15], 0 offen offset:320
    buffer_load_ushort v70, v4, s[12:15], 0 offen offset:384
    buffer_load_ushort v71, v4, s[12:15], 0 offen offset:448
    buffer_load_ushort v72, v4, s[12:15], 0 offen offset:512
    buffer_load_ushort v73, v4, s[12:15], 0 offen offset:576
    buffer_load_ushort v74, v4, s[12:15], 0 offen offset:640
    buffer_load_ushort v75, v4, s[12:15], 0 offen offset:704
    buffer_load_ushort v76, v4, s[12:15], 0 offen offset:768
    buffer_load_ushort v77, v4, s[12:15], 0 offen offset:832
    buffer_load_ushort v78, v4, s[12:15], 0 offen offset:896
    buffer_load_ushort v79, v4, s[12:15], 0 offen offset:960
    v_lshlrev_b32 v5, 3, v3
    buffer_load_ushort v24, v5, s[16:19], 0 offen offset:0
    buffer_load_ushort v40, v5, s[20:23], 0 offen offset:0
    buffer_load_ushort v25, v5, s[16:19], 0 offen offset:2
    buffer_load_ushort v41, v5, s[20:23], 0 offen offset:2
    buffer_load_ushort v26, v5, s[16:19], 0 offen offset:4
    buffer_load_ushort v42, v5, s[20:23], 0 offen offset:4
    buffer_load_ushort v27, v5, s[16:19], 0 offen offset:6
    buffer_load_ushort v43, v5, s[20:23], 0 offen offset:6
    buffer_load_ushort v28, v5, s[16:19], 0 offen offset:16
    buffer_load_ushort v44, v5, s[20:23], 0 offen offset:16
    buffer_load_ushort v29, v5, s[16:19], 0 offen offset:18
    buffer_load_ushort v45, v5, s[20:23], 0 offen offset:18
    buffer_load_ushort v30, v5, s[16:19], 0 offen offset:20
    buffer_load_ushort v46, v5, s[20:23], 0 offen offset:20
    buffer_load_ushort v31, v5, s[16:19], 0 offen offset:22
    buffer_load_ushort v47, v5, s[20:23], 0 offen offset:22
    buffer_load_ushort v32, v5, s[16:19], 0 offen offset:32
    buffer_load_ushort v48, v5, s[20:23], 0 offen offset:32
    buffer_load_ushort v33, v5, s[16:19], 0 offen offset:34
    buffer_load_ushort v49, v5, s[20:23], 0 offen offset:34
    buffer_load_ushort v34, v5, s[16:19], 0 offen offset:36
    buffer_load_ushort v50, v5, s[20:23], 0 offen offset:36
    buffer_load_ushort v35, v5, s[16:19], 0 offen offset:38
    buffer_load_ushort v51, v5, s[20:23], 0 offen offset:38
    buffer_load_ushort v36, v5, s[16:19], 0 offen offset:48
    buffer_load_ushort v52, v5, s[20:23], 0 offen offset:48
    buffer_load_ushort v37, v5, s[16:19], 0 offen offset:50
    buffer_load_ushort v53, v5, s[20:23], 0 offen offset:50
    buffer_load_ushort v38, v5, s[16:19], 0 offen offset:52
    buffer_load_ushort v54, v5, s[20:23], 0 offen offset:52
    buffer_load_ushort v39, v5, s[16:19], 0 offen offset:54
    buffer_load_ushort v55, v5, s[20:23], 0 offen offset:54
    v_lshlrev_b32 v6, 5, v3
    buffer_load_dwordx4 v[56:59], v6, s[24:27], 0 offen
    buffer_load_dwordx4 v[60:63], v6, s[24:27], 0 offen offset:16
    s_waitcnt vmcnt(0)
    v_add_u32 v6, s38, v6
    v_lshl_or_b32 v16, v65, 16, v64
    v_lshl_or_b32 v17, v67, 16, v66
    v_lshl_or_b32 v18, v69, 16, v68
    v_lshl_or_b32 v19, v71, 16, v70
    v_lshl_or_b32 v20, v73, 16, v72
    v_lshl_or_b32 v21, v75, 16, v74
    v_lshl_or_b32 v22, v77, 16, v76
    v_lshl_or_b32 v23, v79, 16, v78
    v_lshlrev_b32 v24, 16, v24
    v_lshlrev_b32 v40, 16, v40
    v_lshlrev_b32 v25, 16, v25
    v_lshlrev_b32 v41, 16, v41
    v_lshlrev_b32 v26, 16, v26
    v_lshlrev_b32 v42, 16, v42
    v_lshlrev_b32 v27, 16, v27
    v_lshlrev_b32 v43, 16, v43
    v_lshlrev_b32 v28, 16, v28
    v_lshlrev_b32 v44, 16, v44
    v_lshlrev_b32 v29, 16, v29
    v_lshlrev_b32 v45, 16, v45
    v_lshlrev_b32 v30, 16, v30
    v_lshlrev_b32 v46, 16, v46
    v_lshlrev_b32 v31, 16, v31
    v_lshlrev_b32 v47, 16, v47
    v_lshlrev_b32 v32, 16, v32
    v_lshlrev_b32 v48, 16, v48
    v_lshlrev_b32 v33, 16, v33
    v_lshlrev_b32 v49, 16, v49
    v_lshlrev_b32 v34, 16, v34
    v_lshlrev_b32 v50, 16, v50
    v_lshlrev_b32 v35, 16, v35
    v_lshlrev_b32 v51, 16, v51
    v_lshlrev_b32 v36, 16, v36
    v_lshlrev_b32 v52, 16, v52
    v_lshlrev_b32 v37, 16, v37
    v_lshlrev_b32 v53, 16, v53
    v_lshlrev_b32 v38, 16, v38
    v_lshlrev_b32 v54, 16, v54
    v_lshlrev_b32 v39, 16, v39
    v_lshlrev_b32 v55, 16, v55
    s_waitcnt lgkmcnt(0)
    v_mov_b32 v12, 0xff7fffff
    v_mov_b32 v13, 0
    v_mov_b32 v14, 0
    v_mov_b32 v7, v2
    s_mov_b32 s60, 0x3fb8aa3b
    s_mov_b32 s61, 0xffff0000
    s_movk_i32 s62, 155
    s_movk_i32 s63, 4950
G_loop:
    v_lshlrev_b32 v8, 2, v7
    buffer_load_dword v9, v8, s[48:51], 0 offen
    buffer_load_dword v10, v8, s[52:55], 0 offen
    s_waitcnt vmcnt(0)
    v_min_u32 v9, 99, v9
    v_min_u32 v10, 99, v10
    v_lshl_add_u32 v9, v9, 6, v6
    v_lshl_add_u32 v10, v10, 6, v6
    ds_read_b128 v[64:67], v9
    ds_read_b128 v[68:71], v9 offset:16
    ds_read_b128 v[72:75], v10
    ds_read_b128 v[76:79], v10 offset:16
    s_waitcnt lgkmcnt(0)
    v_lshlrev_b32 v104, 16, v64
    v_lshlrev_b32 v105, 16, v72
    v_and_b32 v106, s61, v64
    v_and_b32 v107, s61, v72
    v_mul_f32 v104, v104, v105
    v_mul_f32 v106, v106, v107
    v_cvt_pk_bf16_f32 v80, v104, v106
    v_lshlrev_b32 v104, 16, v65
    v_lshlrev_b32 v105, 16, v73
    v_and_b32 v106, s61, v65
    v_and_b32 v107, s61, v73
    v_mul_f32 v104, v104, v105
    v_mul_f32 v106, v106, v107
    v_cvt_pk_bf16_f32 v81, v104, v106
    v_lshlrev_b32 v104, 16, v66
    v_lshlrev_b32 v105, 16, v74
    v_and_b32 v106, s61, v66
    v_and_b32 v107, s61, v74
    v_mul_f32 v104, v104, v105
    v_mul_f32 v106, v106, v107
    v_cvt_pk_bf16_f32 v82, v104, v106
    v_lshlrev_b32 v104, 16, v67
    v_lshlrev_b32 v105, 16, v75
    v_and_b32 v106, s61, v67
    v_and_b32 v107, s61, v75
    v_mul_f32 v104, v104, v105
    v_mul_f32 v106, v106, v107
    v_cvt_pk_bf16_f32 v83, v104, v106
    v_lshlrev_b32 v104, 16, v68
    v_lshlrev_b32 v105, 16, v76
    v_and_b32 v106, s61, v68
    v_and_b32 v107, s61, v76
    v_mul_f32 v104, v104, v105
    v_mul_f32 v106, v106, v107
    v_cvt_pk_bf16_f32 v84, v104, v106
    v_lshlrev_b32 v104, 16, v69
    v_lshlrev_b32 v105, 16, v77
    v_and_b32 v106, s61, v69
    v_and_b32 v107, s61, v77
    v_mul_f32 v104, v104, v105
    v_mul_f32 v106, v106, v107
    v_cvt_pk_bf16_f32 v85, v104, v106
    v_lshlrev_b32 v104, 16, v70
    v_lshlrev_b32 v105, 16, v78
    v_and_b32 v106, s61, v70
    v_and_b32 v107, s61, v78
    v_mul_f32 v104, v104, v105
    v_mul_f32 v106, v106, v107
    v_cvt_pk_bf16_f32 v86, v104, v106
    v_lshlrev_b32 v104, 16, v71
    v_lshlrev_b32 v105, 16, v79
    v_and_b32 v106, s61, v71
    v_and_b32 v107, s61, v79
    v_mul_f32 v104, v104, v105
    v_mul_f32 v106, v106, v107
    v_cvt_pk_bf16_f32 v87, v104, v106
    s_nop 1
    v_mfma_f32_32x32x16_bf16 v[88:103], v[16:19], v[80:83], v[24:39]
    v_mfma_f32_32x32x16_bf16 v[88:103], v[20:23], v[84:87], v[88:103]
    v_mov_b32 v11, 0
    v_lshlrev_b32 v104, 16, v80
    v_lshlrev_b32 v105, 16, v56
    v_and_b32 v106, s61, v80
    v_and_b32 v107, s61, v56
    v_fmac_f32 v11, v104, v105
    v_fmac_f32 v11, v106, v107
    v_lshlrev_b32 v104, 16, v81
    v_lshlrev_b32 v105, 16, v57
    v_and_b32 v106, s61, v81
    v_and_b32 v107, s61, v57
    v_fmac_f32 v11, v104, v105
    v_fmac_f32 v11, v106, v107
    v_lshlrev_b32 v104, 16, v82
    v_lshlrev_b32 v105, 16, v58
    v_and_b32 v106, s61, v82
    v_and_b32 v107, s61, v58
    v_fmac_f32 v11, v104, v105
    v_fmac_f32 v11, v106, v107
    v_lshlrev_b32 v104, 16, v83
    v_lshlrev_b32 v105, 16, v59
    v_and_b32 v106, s61, v83
    v_and_b32 v107, s61, v59
    v_fmac_f32 v11, v104, v105
    v_fmac_f32 v11, v106, v107
    v_lshlrev_b32 v104, 16, v84
    v_lshlrev_b32 v105, 16, v60
    v_and_b32 v106, s61, v84
    v_and_b32 v107, s61, v60
    v_fmac_f32 v11, v104, v105
    v_fmac_f32 v11, v106, v107
    v_lshlrev_b32 v104, 16, v85
    v_lshlrev_b32 v105, 16, v61
    v_and_b32 v106, s61, v85
    v_and_b32 v107, s61, v61
    v_fmac_f32 v11, v104, v105
    v_fmac_f32 v11, v106, v107
    v_lshlrev_b32 v104, 16, v86
    v_lshlrev_b32 v105, 16, v62
    v_and_b32 v106, s61, v86
    v_and_b32 v107, s61, v62
    v_fmac_f32 v11, v104, v105
    v_fmac_f32 v11, v106, v107
    v_lshlrev_b32 v104, 16, v87
    v_lshlrev_b32 v105, 16, v63
    v_and_b32 v106, s61, v87
    v_and_b32 v107, s61, v63
    v_fmac_f32 v11, v104, v105
    v_fmac_f32 v11, v106, v107
    v_mov_b32 v15, 0
    v_add_f32 v104, v88, |v88|
    v_fmac_f32 v15, v104, v40
    v_add_f32 v104, v89, |v89|
    v_fmac_f32 v15, v104, v41
    v_add_f32 v104, v90, |v90|
    v_fmac_f32 v15, v104, v42
    v_add_f32 v104, v91, |v91|
    v_fmac_f32 v15, v104, v43
    v_add_f32 v104, v92, |v92|
    v_fmac_f32 v15, v104, v44
    v_add_f32 v104, v93, |v93|
    v_fmac_f32 v15, v104, v45
    v_add_f32 v104, v94, |v94|
    v_fmac_f32 v15, v104, v46
    v_add_f32 v104, v95, |v95|
    v_fmac_f32 v15, v104, v47
    v_add_f32 v104, v96, |v96|
    v_fmac_f32 v15, v104, v48
    v_add_f32 v104, v97, |v97|
    v_fmac_f32 v15, v104, v49
    v_add_f32 v104, v98, |v98|
    v_fmac_f32 v15, v104, v50
    v_add_f32 v104, v99, |v99|
    v_fmac_f32 v15, v104, v51
    v_add_f32 v104, v100, |v100|
    v_fmac_f32 v15, v104, v52
    v_add_f32 v104, v101, |v101|
    v_fmac_f32 v15, v104, v53
    v_add_f32 v104, v102, |v102|
    v_fmac_f32 v15, v104, v54
    v_add_f32 v104, v103, |v103|
    v_fmac_f32 v15, v104, v55
    v_mul_f32 v15, 0.5, v15
    v_mov_b32 v104, v11
    v_mov_b32 v105, v15
    s_nop 1
    v_permlane32_swap_b32 v11, v104
    v_permlane32_swap_b32 v15, v105
    s_nop 1
    v_add_f32 v11, v11, v104
    v_add_f32 v15, v15, v105
    v_cmp_gt_u32 vcc, s63, v7
    v_mov_b32 v104, 0xff800000
    s_nop 1
    v_cndmask_b32 v15, v104, v15, vcc
    v_cndmask_b32 v11, 0, v11, vcc
    v_max_f32 v104, v12, v15
    v_sub_f32 v105, v12, v104
    v_sub_f32 v106, v15, v104
    v_mul_f32 v105, s60, v105
    v_mul_f32 v106, s60, v106
    v_exp_f32 v105, v105
    v_exp_f32 v106, v106
    v_mov_b32 v12, v104
    v_fma_f32 v13, v13, v105, v106
    v_mul_f32 v106, v106, v11
    v_fma_f32 v14, v14, v105, v106
    v_add_u32 v7, 32, v7
    s_sub_u32 s62, s62, 1
    s_cmp_lg_u32 s62, 0
    s_cbranch_scc1 G_loop
    v_mov_b32 v64, v12
    v_lshlrev_b32 v9, 2, v1
    v_xor_b32 v10, 4, v9
    ds_bpermute_b32 v11, v10, v12
    s_waitcnt lgkmcnt(0)
    v_max_f32 v12, v12, v11
    v_xor_b32 v10, 8, v9
    ds_bpermute_b32 v11, v10, v12
    s_waitcnt lgkmcnt(0)
    v_max_f32 v12, v12, v11
    v_xor_b32 v10, 16, v9
    ds_bpermute_b32 v11, v10, v12
    s_waitcnt lgkmcnt(0)
    v_max_f32 v12, v12, v11
    v_xor_b32 v10, 32, v9
    ds_bpermute_b32 v11, v10, v12
    s_waitcnt lgkmcnt(0)
    v_max_f32 v12, v12, v11
    v_xor_b32 v10, 64, v9
    ds_bpermute_b32 v11, v10, v12
    s_waitcnt lgkmcnt(0)
    v_max_f32 v12, v12, v11
    v_sub_f32 v10, v64, v12
    v_mul_f32 v10, s60, v10
    v_exp_f32 v10, v10
    s_nop 0
    v_mul_f32 v13, v13, v10
    v_mul_f32 v14, v14, v10
    v_xor_b32 v10, 4, v9
    ds_bpermute_b32 v11, v10, v13
    ds_bpermute_b32 v15, v10, v14
    s_waitcnt lgkmcnt(0)
    v_add_f32 v13, v13, v11
    v_add_f32 v14, v14, v15
    v_xor_b32 v10, 8, v9
    ds_bpermute_b32 v11, v10, v13
    ds_bpermute_b32 v15, v10, v14
    s_waitcnt lgkmcnt(0)
    v_add_f32 v13, v13, v11
    v_add_f32 v14, v14, v15
    v_xor_b32 v10, 16, v9
    ds_bpermute_b32 v11, v10, v13
    ds_bpermute_b32 v15, v10, v14
    s_waitcnt lgkmcnt(0)
    v_add_f32 v13, v13, v11
    v_add_f32 v14, v14, v15
    v_xor_b32 v10, 32, v9
    ds_bpermute_b32 v11, v10, v13
    ds_bpermute_b32 v15, v10, v14
    s_waitcnt lgkmcnt(0)
    v_add_f32 v13, v13, v11
    v_add_f32 v14, v14, v15
    v_xor_b32 v10, 64, v9
    ds_bpermute_b32 v11, v10, v13
    ds_bpermute_b32 v15, v10, v14
    s_waitcnt lgkmcnt(0)
    v_add_f32 v13, v13, v11
    v_add_f32 v14, v14, v15
    v_rcp_f32 v13, v13
    s_lshl_b32 s3, s37, 1
    v_mul_f32 v14, v14, v13
    v_mov_b32 v8, s3
    v_cvt_pk_bf16_f32 v14, v14, v14
    s_mov_b64 exec, 1
    buffer_store_short v14, v8, s[28:31], 0 offen
    s_endpgm
    .fill (24576 + 512 - (. - standalone__factorization_afm__recsys_kernel)) / 4, 4, 0xbf810000
.section .rodata,"a"
.p2align 6
.amdhsa_kernel standalone__factorization_afm__recsys_kernel
  .amdhsa_next_free_vgpr 245
  .amdhsa_next_free_sgpr 80
  .amdhsa_accum_offset 248
  .amdhsa_group_segment_fixed_size 0
  .amdhsa_kernarg_size 88
  .amdhsa_user_sgpr_count 2
  .amdhsa_user_sgpr_kernarg_segment_ptr 1
  .amdhsa_system_sgpr_workgroup_id_x 1
.end_amdhsa_kernel
```
